```python
import torch

def _softmax(x, axis=-1):
    return torch.softmax(x, dim=axis)
def _gelu(x):
    return torch.nn.functional.gelu(x, approximate="tanh")
def _silu(x):
    return torch.nn.functional.silu(x)
def _sigmoid(x):
    return torch.sigmoid(x)
def _layernorm(x, axis=-1, eps=1e-5):
    m = x.mean(dim=axis, keepdim=True)
    v = x.var(dim=axis, keepdim=True, unbiased=False)
    return (x - m) / torch.sqrt(v + eps)
def _scatter_add(tgt, idx, src, axis=0):
    return tgt.clone().index_add_(axis, idx, src)
def _segment_sum(src, seg, n):
    out = torch.zeros((n,) + src.shape[1:], dtype=src.dtype)
    return out.index_add_(0, seg, src)
def _pad(x, pw):
    flat = tuple(v for pair in reversed(pw) for v in pair)
    return torch.nn.functional.pad(x, flat)

kernel_name = 'recurrent_scan__compressed_kv_cla__mixer_channel_mlp__decode'

def setup_inputs():

    _w = (lambda a: (lambda t: t.to(torch.bfloat16) if t.is_floating_point() else t)(torch.as_tensor(a)))
    def _A_setup():
        B, H, Sq, Sk, D, M = 2, 32, 1, 8192, 128, 576
        Dc = 4 * D
        return {
            "x": _w((lambda *s: torch.randn(*s, dtype=torch.bfloat16) * 0.1)(B, Sq, M)),
            "c_kv": _w((lambda *s: torch.randn(*s, dtype=torch.bfloat16) * 3.2)(B, Sk, Dc)),
            "w_q": _w((lambda *s: torch.randn(*s, dtype=torch.bfloat16) * 0.8)(M, H, D) * (M ** -0.5)),
            "w_uk": _w((lambda *s: torch.randn(*s, dtype=torch.bfloat16) * 0.8)(Dc, H, D) * (Dc ** -0.5)),
            "w_uv": _w((lambda *s: torch.randn(*s, dtype=torch.bfloat16) * 3.2)(Dc, H, D) * (Dc ** -0.5)),
            "w_o": _w((lambda *s: torch.randn(*s, dtype=torch.bfloat16) * 3.2)(H, D, M) * ((H * D) ** -0.5)),
        }
    _A_in = _A_setup()

    def _B_setup():
        B, S, D, F = 2, 1, 576, 4608
        return {
            "x": _w((lambda *s: torch.randn(*s, dtype=torch.bfloat16) * 0.1)(B, S, D)),
            "w1": _w((lambda *s: torch.randn(*s, dtype=torch.bfloat16) * 3.2)(D, F) * (D ** -0.5)),
            "b1": _w((lambda *s: torch.randn(*s, dtype=torch.bfloat16) * 3.2)(F)),
            "w2": _w((lambda *s: torch.randn(*s, dtype=torch.bfloat16) * 3.2)(F, D) * (F ** -0.5)),
            "b2": _w((lambda *s: torch.randn(*s, dtype=torch.bfloat16) * 3.2)(D)),
        }
    _B_in = _B_setup()

    return {
        "A_x": _A_in["x"],
        "A_c_kv": _A_in["c_kv"],
        "A_w_q": _A_in["w_q"],
        "A_w_uk": _A_in["w_uk"],
        "A_w_uv": _A_in["w_uv"],
        "A_w_o": _A_in["w_o"],
        "B_x": _B_in["x"],
        "B_w1": _B_in["w1"],
        "B_b1": _B_in["b1"],
        "B_w2": _B_in["w2"],
        "B_b2": _B_in["b2"],
    }

def reference(A_x, A_c_kv, A_w_q, A_w_uk, A_w_uv, A_w_o, B_x, B_w1, B_b1, B_w2, B_b2):
    def _A_ref(x, c_kv, w_q, w_uk, w_uv, w_o):
        B, Sq, M = x.shape[0], x.shape[1], x.shape[2]
        Sk = c_kv.shape[1]
        H, D = w_q.shape[1], w_q.shape[2]
        q = torch.einsum("bqm,mhd->bhqd", x, w_q)
        k = torch.einsum("bkc,chd->bhkd", c_kv, w_uk)
        v = torch.einsum("bkc,chd->bhkd", c_kv, w_uv)
        scores = torch.einsum("bhqd,bhkd->bhqk", q, k) * (D ** -0.5)
        off = Sk - Sq
        qi = torch.arange(Sq)[:, None]
        kj = torch.arange(Sk)[None, :]
        cmask = kj <= (qi + off)
        scores = torch.where(cmask[None, None], scores, -1e9)
        p = _softmax(scores, axis=-1)
        ctx = torch.einsum("bhqk,bhkd->bhqd", p, v)
        return torch.einsum("bhqd,hdm->bqm", ctx, w_o)

    def _B_ref(x, w1, b1, w2, b2):
        y = _layernorm(x, axis=-1)
        h = _gelu(torch.einsum("bsd,df->bsf", y, w1) + b1)
        return torch.einsum("bsf,fd->bsd", h, w2) + b2

    x = A_x
    xn = _layernorm(x, axis=-1)
    s = _A_ref(xn, A_c_kv, A_w_q, A_w_uk, A_w_uv, A_w_o)
    g = _silu(_B_ref(xn, B_w1, B_b1, B_w2, B_b2))
    return x + s * g
```

```asm
; @launch grid=(256,1,1) block=(256,1,1) lds=163840
.amdgcn_target "amdgcn-amd-amdhsa--gfx950"
.text
.globl recurrent_scan__compressed_kv_cla__mixer_channel_mlp__decode_kernel
.p2align 12
.p2align 8
.type recurrent_scan__compressed_kv_cla__mixer_channel_mlp__decode_kernel,@function
recurrent_scan__compressed_kv_cla__mixer_channel_mlp__decode_kernel:
    s_load_dwordx2 s[4:5], s[0:1], 104
    s_load_dwordx2 s[20:21], s[0:1], 16
    s_load_dwordx2 s[28:29], s[0:1], 0
    s_load_dwordx2 s[8:9], s[0:1], 8
    s_load_dwordx2 s[12:13], s[0:1], 24
    v_lshrrev_b32 v2, 6, v0
    s_getpc_b64 s[60:61]
L_pc:
    s_lshr_b32 s50, s2, 3
    v_lshl_add_u32 v6, s50, 2, v2
    v_lshlrev_b32 v6, 8, v6
    v_and_b32 v7, 32, v0
    v_lshl_add_u32 v6, v7, 2, v6
    v_min_u32 v6, L_end-L_pc-256, v6
    global_load_dword v6, v6, s[60:61] offset:256
    s_cmp_ge_u32 s2, 256
    s_cbranch_scc1 L_end
    v_and_b32 v1, 63, v0
    s_and_b32 s3, s2, 7
    v_readfirstlane_b32 s34, v2
    s_lshr_b32 s33, s2, 4
    v_lshlrev_b32 v3, 4, v1
    v_lshrrev_b32 v2, 4, v1
    s_lshr_b32 s38, s33, 2
    s_lshl2_add_u32 s38, s3, s38
    s_and_b32 s39, s33, 3
    s_mul_i32 s48, s39, 9
    s_add_u32 s48, s48, 1
    s_lshr_b32 s48, s48, 1
    s_lshl_b32 s44, s48, 18
    s_mov_b32 s22, 4718592
    s_mov_b32 s23, 0x20000
    v_mul_u32_u24 v250, 36, v1
    s_mov_b32 s30, 2304
    s_mov_b32 s31, 0x20000
    s_mov_b32 s14, 4194304
    s_mov_b32 s15, 0x20000
    s_bitcmp1_b32 s2, 3
    s_cbranch_scc0 L_a0
    s_and_b32 s50, s34, 1
    s_lshl_b32 s50, s50, 3
    v_lshl_add_u32 v7, v2, 1, s50
    v_xor_b32 v7, v7, v1
    v_and_b32 v7, 15, v7
    v_lshlrev_b32 v7, 4, v7
    v_lshl_add_u32 v7, v2, 13, v7
    s_lshl_b32 s50, s34, 7
    s_add_u32 s50, s50, s38
    s_lshl_b32 s50, s50, 8
    v_add_u32 v4, s50, v7
    v_add_u32 v5, 130048, v4
    s_lshl_b32 s47, s34, 11
    s_mov_b32 s46, s47
    s_lshl_b32 s53, s39, 20
    s_waitcnt lgkmcnt(0)
    s_cmp_lg_u32 s34, 0
    s_cbranch_scc1 L_b_ld
    buffer_load_dwordx3 v[128:130], v250, s[28:31], 0 offen
    buffer_load_dwordx3 v[132:134], v250, s[28:31], 0 offen offset:12
    buffer_load_dwordx3 v[136:138], v250, s[28:31], 0 offen offset:24
L_b_ld:
    s_mov_b32 m0, s47
    s_add_u32 s47, s47, 8192
    buffer_load_dwordx4 v4, s[20:23], s44 offen lds
    buffer_load_dwordx4 v5, s[20:23], s44 offen offset:1024 lds
    s_add_u32 s44, s44, 0x40000
    s_cmp_eq_u32 s44, 4718592
    s_cselect_b32 s44, 0, s44
    s_cmp_lt_u32 s47, 32768
    s_cbranch_scc1 L_b_ld
    s_cmp_lg_u32 s34, 0
    s_cbranch_scc1 L_b1
    s_waitcnt vmcnt(8)
L_ln:
    v_lshrrev_b32 v56, 5, v1
    v_lshl_add_u32 v250, v56, 3, v250
    v_mul_u32_u24 v56, 1152, v56
    v_add_u32 v56, v56, v250
    v_add_u32 v56, 152576, v56
    s_mov_b32 s49, 0
L_ln_loop:
    v_lshlrev_b32 v140, 16, v128
    v_and_b32 v141, 0xffff0000, v128
    v_lshlrev_b32 v142, 16, v129
    v_and_b32 v143, 0xffff0000, v129
    v_lshlrev_b32 v144, 16, v130
    v_and_b32 v145, 0xffff0000, v130
    v_lshlrev_b32 v146, 16, v132
    v_and_b32 v147, 0xffff0000, v132
    v_lshlrev_b32 v148, 16, v133
    v_and_b32 v149, 0xffff0000, v133
    v_lshlrev_b32 v150, 16, v134
    v_and_b32 v151, 0xffff0000, v134
    v_lshlrev_b32 v152, 16, v136
    v_and_b32 v153, 0xffff0000, v136
    v_lshlrev_b32 v154, 16, v137
    v_and_b32 v155, 0xffff0000, v137
    v_lshlrev_b32 v156, 16, v138
    v_and_b32 v157, 0xffff0000, v138
    v_pk_add_f32 v[52:53], v[140:141], v[142:143]
    v_pk_add_f32 v[52:53], v[52:53], v[144:145]
    v_pk_add_f32 v[52:53], v[52:53], v[146:147]
    v_pk_add_f32 v[52:53], v[52:53], v[148:149]
    v_pk_add_f32 v[52:53], v[52:53], v[150:151]
    v_pk_add_f32 v[52:53], v[52:53], v[152:153]
    v_pk_add_f32 v[52:53], v[52:53], v[154:155]
    v_pk_add_f32 v[52:53], v[52:53], v[156:157]
    v_add_f32 v52, v52, v53
    s_nop 1
    v_add_f32_dpp v52, v52, v52 row_ror:8 row_mask:0xf bank_mask:0xf
    s_nop 1
    v_add_f32_dpp v52, v52, v52 row_ror:4 row_mask:0xf bank_mask:0xf
    s_nop 1
    v_add_f32_dpp v52, v52, v52 row_ror:2 row_mask:0xf bank_mask:0xf
    s_nop 1
    v_add_f32_dpp v52, v52, v52 row_ror:1 row_mask:0xf bank_mask:0xf
    v_mov_b32 v53, v52
    s_nop 1
    v_permlane16_swap_b32 v52, v53
    v_add_f32 v52, v52, v53
    v_mul_f32 v54, 0x3ae38e39, v52
    v_cvt_pk_bf16_f32 v52, v54, v54
    v_and_b32 v52, 0xffff0000, v52
    v_sub_f32 v54, v54, v52
    v_pk_add_f32 v[140:141], v[140:141], v[52:53] op_sel_hi:[1,0] neg_lo:[0,1] neg_hi:[0,1]
    v_pk_add_f32 v[142:143], v[142:143], v[52:53] op_sel_hi:[1,0] neg_lo:[0,1] neg_hi:[0,1]
    v_pk_add_f32 v[144:145], v[144:145], v[52:53] op_sel_hi:[1,0] neg_lo:[0,1] neg_hi:[0,1]
    v_pk_add_f32 v[146:147], v[146:147], v[52:53] op_sel_hi:[1,0] neg_lo:[0,1] neg_hi:[0,1]
    v_pk_add_f32 v[148:149], v[148:149], v[52:53] op_sel_hi:[1,0] neg_lo:[0,1] neg_hi:[0,1]
    v_pk_add_f32 v[150:151], v[150:151], v[52:53] op_sel_hi:[1,0] neg_lo:[0,1] neg_hi:[0,1]
    v_pk_add_f32 v[152:153], v[152:153], v[52:53] op_sel_hi:[1,0] neg_lo:[0,1] neg_hi:[0,1]
    v_pk_add_f32 v[154:155], v[154:155], v[52:53] op_sel_hi:[1,0] neg_lo:[0,1] neg_hi:[0,1]
    v_pk_add_f32 v[156:157], v[156:157], v[52:53] op_sel_hi:[1,0] neg_lo:[0,1] neg_hi:[0,1]
    v_pk_mul_f32 v[52:53], v[140:141], v[140:141]
    v_pk_fma_f32 v[52:53], v[142:143], v[142:143], v[52:53]
    v_pk_fma_f32 v[52:53], v[144:145], v[144:145], v[52:53]
    v_pk_fma_f32 v[52:53], v[146:147], v[146:147], v[52:53]
    v_pk_fma_f32 v[52:53], v[148:149], v[148:149], v[52:53]
    v_pk_fma_f32 v[52:53], v[150:151], v[150:151], v[52:53]
    v_pk_fma_f32 v[52:53], v[152:153], v[152:153], v[52:53]
    v_pk_fma_f32 v[52:53], v[154:155], v[154:155], v[52:53]
    v_pk_fma_f32 v[52:53], v[156:157], v[156:157], v[52:53]
    v_add_f32 v52, v52, v53
    v_cvt_pk_bf16_f32 v128, v140, v141
    v_lshlrev_b32 v140, 16, v128
    v_and_b32 v141, 0xffff0000, v128
    v_add_f32_dpp v52, v52, v52 row_ror:8 row_mask:0xf bank_mask:0xf
    v_cvt_pk_bf16_f32 v129, v142, v143
    v_lshlrev_b32 v142, 16, v129
    v_and_b32 v143, 0xffff0000, v129
    v_add_f32_dpp v52, v52, v52 row_ror:4 row_mask:0xf bank_mask:0xf
    v_cvt_pk_bf16_f32 v130, v144, v145
    v_lshlrev_b32 v144, 16, v130
    v_and_b32 v145, 0xffff0000, v130
    v_add_f32_dpp v52, v52, v52 row_ror:2 row_mask:0xf bank_mask:0xf
    v_cvt_pk_bf16_f32 v132, v146, v147
    v_lshlrev_b32 v146, 16, v132
    v_and_b32 v147, 0xffff0000, v132
    v_add_f32_dpp v52, v52, v52 row_ror:1 row_mask:0xf bank_mask:0xf
    v_cvt_pk_bf16_f32 v133, v148, v149
    v_lshlrev_b32 v148, 16, v133
    v_and_b32 v149, 0xffff0000, v133
    v_mov_b32 v53, v52
    v_cvt_pk_bf16_f32 v134, v150, v151
    v_lshlrev_b32 v150, 16, v134
    v_and_b32 v151, 0xffff0000, v134
    v_permlane16_swap_b32 v52, v53
    v_add_f32 v52, v52, v53
    v_cvt_pk_bf16_f32 v136, v152, v153
    v_lshlrev_b32 v152, 16, v136
    v_and_b32 v153, 0xffff0000, v136
    v_mul_f32 v52, 0x3ae38e39, v52
    v_fma_f32 v52, -v54, v54, v52
    v_cvt_pk_bf16_f32 v52, v52, v52
    v_and_b32 v52, 0xffff0000, v52
    v_add_f32 v52, 0x3727c5ac, v52
    v_cvt_pk_bf16_f32 v52, v52, v52
    v_and_b32 v52, 0xffff0000, v52
    v_sqrt_f32 v52, v52
    v_cvt_pk_bf16_f32 v137, v154, v155
    v_lshlrev_b32 v154, 16, v137
    v_and_b32 v155, 0xffff0000, v137
    v_cvt_pk_bf16_f32 v52, v52, v52
    v_and_b32 v52, 0xffff0000, v52
    v_rcp_f32 v52, v52
    v_cvt_pk_bf16_f32 v138, v156, v157
    v_lshlrev_b32 v156, 16, v138
    v_and_b32 v157, 0xffff0000, v138
    v_pk_mul_f32 v[140:141], v[140:141], v[52:53] op_sel_hi:[1,0]
    v_cvt_pk_bf16_f32 v128, v140, v141
    v_pk_mul_f32 v[142:143], v[142:143], v[52:53] op_sel_hi:[1,0]
    v_cvt_pk_bf16_f32 v129, v142, v143
    v_pk_mul_f32 v[144:145], v[144:145], v[52:53] op_sel_hi:[1,0]
    v_cvt_pk_bf16_f32 v130, v144, v145
    v_pk_mul_f32 v[146:147], v[146:147], v[52:53] op_sel_hi:[1,0]
    v_cvt_pk_bf16_f32 v132, v146, v147
    v_pk_mul_f32 v[148:149], v[148:149], v[52:53] op_sel_hi:[1,0]
    v_cvt_pk_bf16_f32 v133, v148, v149
    v_pk_mul_f32 v[150:151], v[150:151], v[52:53] op_sel_hi:[1,0]
    v_cvt_pk_bf16_f32 v134, v150, v151
    v_pk_mul_f32 v[152:153], v[152:153], v[52:53] op_sel_hi:[1,0]
    v_cvt_pk_bf16_f32 v136, v152, v153
    v_pk_mul_f32 v[154:155], v[154:155], v[52:53] op_sel_hi:[1,0]
    v_cvt_pk_bf16_f32 v137, v154, v155
    v_pk_mul_f32 v[156:157], v[156:157], v[52:53] op_sel_hi:[1,0]
    v_cvt_pk_bf16_f32 v138, v156, v157
    ds_write2_b32 v56, v128, v129 offset0:0 offset1:1
    ds_write2_b32 v56, v130, v132 offset0:2 offset1:3
    ds_write2_b32 v56, v133, v134 offset0:4 offset1:5
    ds_write2_b32 v56, v136, v137 offset0:6 offset1:7
    ds_write_b32 v56, v138 offset:32
    s_cmp_lg_u32 s49, 0
    s_cbranch_scc1 L_b_y
    v_add_u32 v56, 1152, v56
    ds_write2_b32 v56, v128, v129 offset0:0 offset1:1
    ds_write2_b32 v56, v130, v132 offset0:2 offset1:3
    ds_write2_b32 v56, v133, v134 offset0:4 offset1:5
    ds_write2_b32 v56, v136, v137 offset0:6 offset1:7
    ds_write_b32 v56, v138 offset:32
L_b1:
    s_mov_b64 s[40:41], s[8:9]
    s_mov_b32 s42, 16777216
    s_mov_b32 s43, 0x20000
    s_load_dword s35, s[4:5], 0
    s_load_dwordx2 s[8:9], s[0:1], 56
    s_load_dwordx2 s[16:17], s[0:1], 40
    s_load_dwordx2 s[24:25], s[0:1], 32
    s_mov_b32 s6, 268435456
    s_mov_b32 s7, 0x20000
    s_mov_b32 s10, 5308416
    s_mov_b32 s11, 0x20000
    s_mov_b32 s18, 4718592
    s_mov_b32 s19, 0x20000
    s_mov_b32 s26, 4194304
    s_mov_b32 s27, 0x20000
    v_bfe_u32 v55, v1, 2, 2
    v_and_b32 v56, 3, v1
    v_and_b32 v57, 1, v1
    v_lshlrev_b32 v52, 2, v56
    v_xor_b32 v52, v52, v2
    v_lshlrev_b32 v52, 4, v52
    v_lshl_add_u32 v52, v57, 9, v52
    v_bfe_u32 v53, v1, 1, 2
    v_lshl_add_u32 v52, v53, 11, v52
    v_bfe_u32 v53, v1, 3, 1
    v_lshl_add_u32 v52, v53, 10, v52
    s_lshl_b32 s50, s34, 13
    s_add_u32 s50, s50, 114688
    v_add_u32 v200, s50, v52
    v_xor_b32 v201, 64, v200
    v_xor_b32 v202, 128, v200
    v_xor_b32 v203, 192, v200
    v_xor_b32 v204, 288, v200
    v_xor_b32 v205, 352, v200
    v_xor_b32 v206, 416, v200
    v_xor_b32 v207, 480, v200
    v_bfe_u32 v52, v1, 2, 3
    v_lshlrev_b32 v52, 5, v52
    v_lshl_add_u32 v52, v56, 3, v52
    v_lshl_add_u32 v52, v55, 8, v52
    v_lshl_add_u32 v52, v2, 11, v52
    s_lshl_b32 s50, s34, 6
    v_xor_b32 v208, s50, v52
    v_xor_b32 v209, 32, v208
    v_add_u32 v210, 0x10000, v208
    v_add_u32 v211, 0x10000, v209
    v_mul_u32_u24 v52, 2312, v57
    v_lshl_add_u32 v52, v2, 3, v52
    s_lshl_b32 s51, s48, 6
    s_add_u32 s51, s51, 152576
    v_add_u32 v214, s51, v52
    v_mul_u32_u24 v52, 320, v57
    v_lshl_add_u32 v52, v2, 3, v52
    s_add_u32 s50, s50, 159520
    v_add_u32 v215, s50, v52
    v_bfe_u32 v53, v1, 2, 1
    v_mul_u32_u24 v52, 320, v53
    v_lshl_add_u32 v52, v2, 4, v52
    v_add_u32 v216, 159520, v52
    v_and_b32 v52, 15, v1
    v_lshlrev_b32 v52, 3, v52
    v_lshl_add_u32 v52, v2, 16, v52
    s_lshr_b32 s55, s38, 4
    s_and_b32 s56, s38, 15
    s_lshl2_add_u32 s50, s55, s39
    s_lshl2_add_u32 s50, s50, s34
    s_lshl4_add_u32 s50, s50, s56
    s_lshl_b32 s50, s50, 7
    s_add_u32 s50, s50, 4096
    v_add_u32 v217, s50, v52
    s_and_b32 s57, s39, 2
    s_add_u32 m0, s46, 32768
    s_nop 0
    buffer_load_dwordx4 v4, s[20:23], s44 offen  lds
    buffer_load_dwordx4 v5, s[20:23], s44 offen offset:1024  lds
    s_add_u32 s44, s44, 0x40000
    s_cmp_eq_u32 s44, 4718592
    s_cselect_b32 s44, 0, s44
    s_add_u32 m0, s46, 40960
    s_nop 0
    buffer_load_dwordx4 v4, s[20:23], s44 offen  lds
    buffer_load_dwordx4 v5, s[20:23], s44 offen offset:1024  lds
    s_add_u32 s44, s44, 0x40000
    s_cmp_eq_u32 s44, 4718592
    s_cselect_b32 s44, 0, s44
    s_add_u32 m0, s46, 49152
    s_nop 0
    buffer_load_dwordx4 v4, s[20:23], s44 offen  lds
    buffer_load_dwordx4 v5, s[20:23], s44 offen offset:1024  lds
    s_add_u32 s44, s44, 0x40000
    s_cmp_eq_u32 s44, 4718592
    s_cselect_b32 s44, 0, s44
    s_add_u32 m0, s46, 57344
    s_nop 0
    buffer_load_dwordx4 v4, s[20:23], s44 offen  lds
    buffer_load_dwordx4 v5, s[20:23], s44 offen offset:1024  lds
    s_add_u32 s44, s44, 0x40000
    s_cmp_eq_u32 s44, 4718592
    s_cselect_b32 s44, 0, s44
    v_lshrrev_b32 v52, 3, v1
    v_mul_u32_u24 v52, 57, v52
    s_mov_b32 s50, 8064
    v_add_u32 v54, 0, v52
    v_lshrrev_b32 v55, 5, v54
    v_and_b32 v55, 0x60, v55
    v_lshrrev_b32 v54, 9, v54
    v_xor_b32 v220, v55, v3
    v_mad_u32_u24 v230, v54, s50, v220
    v_add_u32 v54, 456, v52
    v_lshrrev_b32 v55, 5, v54
    v_and_b32 v55, 0x60, v55
    v_lshrrev_b32 v54, 9, v54
    v_xor_b32 v221, v55, v3
    v_mad_u32_u24 v231, v54, s50, v221
    v_add_u32 v54, 912, v52
    v_lshrrev_b32 v55, 5, v54
    v_and_b32 v55, 0x60, v55
    v_lshrrev_b32 v54, 9, v54
    v_xor_b32 v222, v55, v3
    v_mad_u32_u24 v232, v54, s50, v222
    v_add_u32 v54, 1368, v52
    v_lshrrev_b32 v55, 5, v54
    v_and_b32 v55, 0x60, v55
    v_lshrrev_b32 v54, 9, v54
    v_xor_b32 v223, v55, v3
    v_mad_u32_u24 v233, v54, s50, v223
    v_add_u32 v54, 1824, v52
    v_lshrrev_b32 v55, 5, v54
    v_and_b32 v55, 0x60, v55
    v_lshrrev_b32 v54, 9, v54
    s_movk_i32 s51, 4096
    v_xad_u32 v224, v55, v3, s51
    v_mad_u32_u24 v234, v54, s50, v224
    v_add_u32 v54, 2280, v52
    v_lshrrev_b32 v55, 5, v54
    v_and_b32 v55, 0x60, v55
    v_lshrrev_b32 v54, 9, v54
    s_movk_i32 s51, 4096
    v_xad_u32 v225, v55, v3, s51
    v_mad_u32_u24 v235, v54, s50, v225
    v_add_u32 v54, 2736, v52
    v_lshrrev_b32 v55, 5, v54
    v_and_b32 v55, 0x60, v55
    v_lshrrev_b32 v54, 9, v54
    s_movk_i32 s51, 4096
    v_xad_u32 v226, v55, v3, s51
    v_mad_u32_u24 v236, v54, s50, v226
    v_add_u32 v54, 3192, v52
    v_lshrrev_b32 v55, 5, v54
    v_and_b32 v55, 0x60, v55
    v_lshrrev_b32 v54, 9, v54
    s_movk_i32 s51, 4096
    v_xad_u32 v227, v55, v3, s51
    v_mad_u32_u24 v237, v54, s50, v227
    v_add_u32 v54, 3648, v52
    v_lshrrev_b32 v55, 5, v54
    v_and_b32 v55, 0x60, v55
    v_lshrrev_b32 v54, 9, v54
    s_movk_i32 s51, 8192
    v_xad_u32 v228, v55, v3, s51
    v_mad_u32_u24 v238, v54, s50, v228
    s_mul_i32 s51, s34, 456
    v_add_u32 v54, s51, v52
    v_lshrrev_b32 v55, 5, v54
    v_and_b32 v55, 0x60, v55
    v_lshrrev_b32 v54, 9, v54
    s_lshl_b32 s51, s34, 10
    v_xad_u32 v55, v55, v3, s51
    v_mad_u32_u24 v239, v54, s50, v55
    v_lshlrev_b32 v52, 5, v2
    v_xor_b32 v52, v52, v3
    v_and_b32 v52, 0x70, v52
    v_lshrrev_b32 v53, 3, v1
    v_lshl_add_u32 v52, v53, 13, v52
    s_lshl4_add_u32 s50, s57, s34
    s_lshl_b32 s50, s50, 8
    s_add_u32 s50, s50, s38
    s_and_b32 s51, s39, 1
    s_lshl1_add_u32 s50, s50, s51
    s_lshl_b32 s50, s50, 7
    v_add_u32 v218, s50, v52
    s_mul_i32 s62, s34, 9216
    s_lshl1_add_u32 s50, s38, s51
    s_mul_i32 s50, s50, 73728
    s_add_u32 s50, s50, s62
    s_mul_i32 s51, s57, 18432
    s_add_u32 s58, s50, s51
    s_xor_b32 s51, s57, 2
    s_mul_i32 s51, s51, 18432
    s_add_u32 s59, s50, s51
    s_mul_i32 s63, s33, 331776
    s_mul_i32 s51, s3, 1152
    s_add_u32 s63, s63, s51
    s_add_u32 s45, s63, 294912
    s_lshl3_add_u32 s63, s62, s63
    s_lshl_b32 s48, s34, 10
    s_branch L_pg0
.p2align 12
L_pg0:
    s_waitcnt vmcnt(8) lgkmcnt(0)
    s_barrier
    s_add_u32 m0, s46, 65536
    s_nop 0
    buffer_load_dwordx4 v4, s[20:23], s44 offen  lds
    buffer_load_dwordx4 v5, s[20:23], s44 offen offset:1024  lds
    s_add_u32 s44, s44, 0x40000
    s_cmp_eq_u32 s44, 4718592
    s_cselect_b32 s44, 0, s44
    ds_read2_b64 a[0:3], v214 offset0:0 offset1:4
    s_add_u32 m0, s46, 73728
    s_nop 0
    buffer_load_dwordx4 v4, s[20:23], s44 offen  lds
    ds_read_b64_tr_b16 a[72:73], v208 offset:0
    ds_read_b64_tr_b16 a[74:75], v208 offset:1024
    buffer_load_dwordx4 v5, s[20:23], s44 offen offset:1024  lds
    s_add_u32 s44, s44, 0x40000
    s_cmp_eq_u32 s44, 4718592
    s_cselect_b32 s44, 0, s44
    ds_read_b64_tr_b16 a[76:77], v209 offset:0
    ds_read_b64_tr_b16 a[78:79], v209 offset:1024
    s_add_u32 m0, s46, 81920
    s_nop 0
    buffer_load_dwordx4 v4, s[20:23], s44 offen  lds
    ds_read2_b64 a[4:7], v214 offset0:8 offset1:12
    ds_read_b64_tr_b16 a[80:81], v208 offset:8192
    buffer_load_dwordx4 v5, s[20:23], s44 offen offset:1024  lds
    s_add_u32 s44, s44, 0x40000
    s_cmp_eq_u32 s44, 4718592
    s_cselect_b32 s44, 0, s44
    ds_read_b64_tr_b16 a[82:83], v208 offset:9216
    ds_read_b64_tr_b16 a[84:85], v209 offset:8192
    s_add_u32 m0, s46, 90112
    s_nop 0
    buffer_load_dwordx4 v4, s[20:23], s44 offen  lds
    ds_read_b64_tr_b16 a[86:87], v209 offset:9216
    ds_read2_b64 a[8:11], v214 offset0:16 offset1:20
    buffer_load_dwordx4 v5, s[20:23], s44 offen offset:1024  lds
    s_add_u32 s44, s44, 0x40000
    s_cmp_eq_u32 s44, 4718592
    s_cselect_b32 s44, 0, s44
    ds_read_b64_tr_b16 a[88:89], v208 offset:16384
    ds_read_b64_tr_b16 a[90:91], v208 offset:17408
    ds_read_b64_tr_b16 a[92:93], v209 offset:16384
    ds_read_b64_tr_b16 a[94:95], v209 offset:17408
    s_waitcnt lgkmcnt(12)
    v_mfma_f32_16x16x32_bf16 v[64:67], a[72:75], a[0:3], 0
    s_waitcnt lgkmcnt(10)
    v_mfma_f32_16x16x32_bf16 v[68:71], a[76:79], a[0:3], 0
    ds_read2_b64 a[12:15], v214 offset0:24 offset1:28
    ds_read_b64_tr_b16 a[96:97], v208 offset:24576
    ds_read_b64_tr_b16 a[98:99], v208 offset:25600
    ds_read_b64_tr_b16 a[100:101], v209 offset:24576
    ds_read_b64_tr_b16 a[102:103], v209 offset:25600
    s_waitcnt lgkmcnt(12)
    v_mfma_f32_16x16x32_bf16 v[64:67], a[80:83], a[4:7], v[64:67]
    s_waitcnt lgkmcnt(10)
    v_mfma_f32_16x16x32_bf16 v[68:71], a[84:87], a[4:7], v[68:71]
    ds_read2_b64 a[16:19], v214 offset0:32 offset1:36
    ds_read2_b64 a[20:23], v214 offset0:40 offset1:44
    ds_read2_b64 a[24:27], v214 offset0:48 offset1:52
    ds_read2_b64 a[28:31], v214 offset0:56 offset1:60
    ds_read2_b64 a[32:35], v214 offset0:64 offset1:68
    s_waitcnt lgkmcnt(12)
    v_mfma_f32_16x16x32_bf16 v[64:67], a[88:91], a[8:11], v[64:67]
    s_waitcnt lgkmcnt(10)
    v_mfma_f32_16x16x32_bf16 v[68:71], a[92:95], a[8:11], v[68:71]
    s_waitcnt lgkmcnt(7)
    v_mfma_f32_16x16x32_bf16 v[64:67], a[96:99], a[12:15], v[64:67]
    s_waitcnt lgkmcnt(5)
    v_mfma_f32_16x16x32_bf16 v[68:71], a[100:103], a[12:15], v[68:71]
    s_mul_i32 s36, s35, 0x41c64e6d
    s_add_u32 s36, s36, 0x3c6ef35f
    s_mul_i32 s37, s36, 0x2c9277b5
    s_add_u32 s37, s37, 0xac564b05
    v_mov_b32 v82, s36
    v_mov_b32 v83, s37
    v_and_b32 v84, 2, v1
    v_cmp_ne_u32 vcc, 0, v84
    s_waitcnt vmcnt(8)
    s_barrier
    s_add_u32 m0, s46, 98304
    s_nop 0
    buffer_load_dwordx4 v4, s[20:23], s44 offen  lds
    buffer_load_dwordx4 v5, s[20:23], s44 offen offset:1024  lds
    s_add_u32 s44, s44, 0x40000
    s_cmp_eq_u32 s44, 4718592
    s_cselect_b32 s44, 0, s44
    ds_read_b64_tr_b16 a[104:105], v208 offset:32768
    s_add_u32 m0, s46, 106496
    s_nop 0
    buffer_load_dwordx4 v4, s[20:23], s44 offen  lds
    ds_read_b64_tr_b16 a[106:107], v208 offset:33792
    ds_read_b64_tr_b16 a[108:109], v209 offset:32768
    buffer_load_dwordx4 v5, s[20:23], s44 offen offset:1024  lds
    s_add_u32 s44, s44, 0x40000
    s_cmp_eq_u32 s44, 4718592
    s_cselect_b32 s44, 0, s44
    ds_read_b64_tr_b16 a[110:111], v209 offset:33792
    ds_read_b64_tr_b16 a[112:113], v208 offset:40960
    s_add_u32 m0, s46, 0
    s_nop 0
    buffer_load_dwordx4 v4, s[20:23], s44 offen  lds
    ds_read_b64_tr_b16 a[114:115], v208 offset:41984
    ds_read_b64_tr_b16 a[116:117], v209 offset:40960
    buffer_load_dwordx4 v5, s[20:23], s44 offen offset:1024  lds
    s_add_u32 s44, s44, 0x40000
    s_cmp_eq_u32 s44, 4718592
    s_cselect_b32 s44, 0, s44
    ds_read_b64_tr_b16 a[118:119], v209 offset:41984
    ds_read_b64_tr_b16 a[120:121], v208 offset:49152
    ds_read_b64_tr_b16 a[122:123], v208 offset:50176
    ds_read_b64_tr_b16 a[124:125], v209 offset:49152
    ds_read_b64_tr_b16 a[126:127], v209 offset:50176
    s_waitcnt lgkmcnt(10)
    v_mfma_f32_16x16x32_bf16 v[64:67], a[104:107], a[16:19], v[64:67]
    s_waitcnt lgkmcnt(8)
    v_mfma_f32_16x16x32_bf16 v[68:71], a[108:111], a[16:19], v[68:71]
    ds_read_b64_tr_b16 a[128:129], v208 offset:57344
    ds_read_b64_tr_b16 a[130:131], v208 offset:58368
    ds_read_b64_tr_b16 a[132:133], v209 offset:57344
    ds_read_b64_tr_b16 a[134:135], v209 offset:58368
    s_waitcnt lgkmcnt(10)
    v_mfma_f32_16x16x32_bf16 v[64:67], a[112:115], a[20:23], v[64:67]
    s_waitcnt lgkmcnt(8)
    v_mfma_f32_16x16x32_bf16 v[68:71], a[116:119], a[20:23], v[68:71]
    ds_read2_b64 a[36:39], v214 offset0:72 offset1:76
    ds_read2_b64 a[40:43], v214 offset0:80 offset1:84
    ds_read2_b64 a[44:47], v214 offset0:88 offset1:92
    ds_read2_b64 a[48:51], v214 offset0:96 offset1:100
    ds_read2_b64 a[52:55], v214 offset0:104 offset1:108
    s_waitcnt lgkmcnt(11)
    v_mfma_f32_16x16x32_bf16 v[64:67], a[120:123], a[24:27], v[64:67]
    s_waitcnt lgkmcnt(9)
    v_mfma_f32_16x16x32_bf16 v[68:71], a[124:127], a[24:27], v[68:71]
    s_waitcnt lgkmcnt(7)
    v_mfma_f32_16x16x32_bf16 v[64:67], a[128:131], a[28:31], v[64:67]
    s_waitcnt lgkmcnt(5)
    v_mfma_f32_16x16x32_bf16 v[68:71], a[132:135], a[28:31], v[68:71]
    s_waitcnt vmcnt(8)
    s_barrier
    s_add_u32 m0, s46, 8192
    s_nop 0
    buffer_load_dwordx4 v4, s[20:23], s44 offen  lds
    buffer_load_dwordx4 v5, s[20:23], s44 offen offset:1024  lds
    s_add_u32 s44, s44, 0x40000
    s_cmp_eq_u32 s44, 4718592
    s_cselect_b32 s44, 0, s44
    ds_read_b64_tr_b16 a[136:137], v210 offset:0
    s_add_u32 m0, s46, 16384
    s_nop 0
    buffer_load_dwordx4 v4, s[20:23], s44 offen  lds
    ds_read_b64_tr_b16 a[138:139], v210 offset:1024
    ds_read_b64_tr_b16 a[140:141], v211 offset:0
    buffer_load_dwordx4 v5, s[20:23], s44 offen offset:1024  lds
    s_add_u32 s44, s44, 0x40000
    s_cmp_eq_u32 s44, 4718592
    s_cselect_b32 s44, 0, s44
    ds_read_b64_tr_b16 a[142:143], v211 offset:1024
    ds_read_b64_tr_b16 a[144:145], v210 offset:8192
    s_add_u32 m0, s46, 24576
    s_nop 0
    buffer_load_dwordx4 v4, s[20:23], s44 offen  lds
    ds_read_b64_tr_b16 a[146:147], v210 offset:9216
    ds_read_b64_tr_b16 a[148:149], v211 offset:8192
    buffer_load_dwordx4 v5, s[20:23], s44 offen offset:1024  lds
    ds_read_b64_tr_b16 a[150:151], v211 offset:9216
    ds_read_b64_tr_b16 a[152:153], v210 offset:16384
    ds_read_b64_tr_b16 a[154:155], v210 offset:17408
    ds_read_b64_tr_b16 a[156:157], v211 offset:16384
    ds_read_b64_tr_b16 a[158:159], v211 offset:17408
    s_waitcnt lgkmcnt(10)
    v_mfma_f32_16x16x32_bf16 v[64:67], a[136:139], a[32:35], v[64:67]
    s_waitcnt lgkmcnt(8)
    v_mfma_f32_16x16x32_bf16 v[68:71], a[140:143], a[32:35], v[68:71]
    ds_read2_b64 a[56:59], v214 offset0:112 offset1:116
    ds_read2_b64 a[60:63], v214 offset0:120 offset1:124
    ds_read2_b64 a[64:67], v214 offset0:128 offset1:132
    ds_read2_b64 a[68:71], v214 offset0:136 offset1:140
    s_waitcnt lgkmcnt(10)
    v_mfma_f32_16x16x32_bf16 v[64:67], a[144:147], a[36:39], v[64:67]
    s_waitcnt lgkmcnt(8)
    v_mfma_f32_16x16x32_bf16 v[68:71], a[148:151], a[36:39], v[68:71]
    s_waitcnt lgkmcnt(6)
    v_mfma_f32_16x16x32_bf16 v[64:67], a[152:155], a[40:43], v[64:67]
    s_waitcnt lgkmcnt(4)
    v_mfma_f32_16x16x32_bf16 v[68:71], a[156:159], a[40:43], v[68:71]
    s_waitcnt vmcnt(8)
    s_barrier
    s_add_u32 m0, s46, 114688
    s_nop 0
    buffer_load_dwordx4 v4, s[12:15], s53 offen nt lds
    buffer_load_dwordx4 v5, s[12:15], s53 offen offset:1024 nt lds
    s_add_u32 s53, s53, 0x40000
    ds_read_b64_tr_b16 a[160:161], v210 offset:24576
    s_add_u32 m0, s46, 122880
    s_nop 0
    buffer_load_dwordx4 v4, s[12:15], s53 offen nt lds
    ds_read_b64_tr_b16 a[162:163], v210 offset:25600
    ds_read_b64_tr_b16 a[164:165], v211 offset:24576
    buffer_load_dwordx4 v5, s[12:15], s53 offen offset:1024 nt lds
    s_add_u32 s53, s53, 0x40000
    ds_read_b64_tr_b16 a[166:167], v211 offset:25600
    ds_read_b64_tr_b16 a[168:169], v210 offset:32768
    s_add_u32 m0, s46, 131072
    s_nop 0
    buffer_load_dwordx4 v4, s[12:15], s53 offen nt lds
    ds_read_b64_tr_b16 a[170:171], v210 offset:33792
    ds_read_b64_tr_b16 a[172:173], v211 offset:32768
    buffer_load_dwordx4 v5, s[12:15], s53 offen offset:1024 nt lds
    s_add_u32 s53, s53, 0x40000
    ds_read_b64_tr_b16 a[174:175], v211 offset:33792
    ds_read_b64_tr_b16 a[176:177], v210 offset:40960
    s_add_u32 m0, s46, 139264
    s_nop 0
    buffer_load_dwordx4 v4, s[12:15], s53 offen nt lds
    ds_read_b64_tr_b16 a[178:179], v210 offset:41984
    ds_read_b64_tr_b16 a[180:181], v211 offset:40960
    buffer_load_dwordx4 v5, s[12:15], s53 offen offset:1024 nt lds
    s_add_u32 s53, s53, 0x40000
    ds_read_b64_tr_b16 a[182:183], v211 offset:41984
    s_waitcnt lgkmcnt(10)
    v_mfma_f32_16x16x32_bf16 v[64:67], a[160:163], a[44:47], v[64:67]
    s_waitcnt lgkmcnt(8)
    v_mfma_f32_16x16x32_bf16 v[68:71], a[164:167], a[44:47], v[68:71]
    s_waitcnt lgkmcnt(6)
    v_mfma_f32_16x16x32_bf16 v[64:67], a[168:171], a[48:51], v[64:67]
    s_waitcnt lgkmcnt(4)
    v_mfma_f32_16x16x32_bf16 v[68:71], a[172:175], a[48:51], v[68:71]
    s_waitcnt lgkmcnt(2)
    v_mfma_f32_16x16x32_bf16 v[64:67], a[176:179], a[52:55], v[64:67]
    s_waitcnt lgkmcnt(0)
    v_mfma_f32_16x16x32_bf16 v[68:71], a[180:183], a[52:55], v[68:71]
    s_waitcnt vmcnt(8)
    s_barrier
    ds_read_b64_tr_b16 a[184:185], v208 offset:0
    ds_read_b64_tr_b16 a[186:187], v208 offset:1024
    ds_read_b64_tr_b16 a[188:189], v209 offset:0
    ds_read_b64_tr_b16 a[190:191], v209 offset:1024
    ds_read_b64_tr_b16 a[192:193], v208 offset:8192
    ds_read_b64_tr_b16 a[194:195], v208 offset:9216
    ds_read_b64_tr_b16 a[196:197], v209 offset:8192
    ds_read_b64_tr_b16 a[198:199], v209 offset:9216
    ds_read_b64_tr_b16 a[200:201], v208 offset:16384
    ds_read_b64_tr_b16 a[202:203], v208 offset:17408
    ds_read_b64_tr_b16 a[204:205], v209 offset:16384
    ds_read_b64_tr_b16 a[206:207], v209 offset:17408
    s_waitcnt lgkmcnt(10)
    v_mfma_f32_16x16x32_bf16 v[64:67], a[184:187], a[56:59], v[64:67]
    s_waitcnt lgkmcnt(8)
    v_mfma_f32_16x16x32_bf16 v[68:71], a[188:191], a[56:59], v[68:71]
    ds_read_b64_tr_b16 a[208:209], v208 offset:24576
    ds_read_b64_tr_b16 a[210:211], v208 offset:25600
    ds_read_b64_tr_b16 a[212:213], v209 offset:24576
    ds_read_b64_tr_b16 a[214:215], v209 offset:25600
    s_waitcnt lgkmcnt(10)
    v_mfma_f32_16x16x32_bf16 v[64:67], a[192:195], a[60:63], v[64:67]
    s_waitcnt lgkmcnt(8)
    v_mfma_f32_16x16x32_bf16 v[68:71], a[196:199], a[60:63], v[68:71]
    s_waitcnt lgkmcnt(6)
    v_mfma_f32_16x16x32_bf16 v[64:67], a[200:203], a[64:67], v[64:67]
    s_waitcnt lgkmcnt(4)
    v_mfma_f32_16x16x32_bf16 v[68:71], a[204:207], a[64:67], v[68:71]
    s_waitcnt lgkmcnt(2)
    v_mfma_f32_16x16x32_bf16 v[64:67], a[208:211], a[68:71], v[64:67]
    s_waitcnt lgkmcnt(0)
    v_mfma_f32_16x16x32_bf16 v[68:71], a[212:215], a[68:71], v[68:71]
    s_nop 5
    v_cvt_pk_bf16_f32 v72, v64, v65
    v_cvt_pk_bf16_f32 v73, v66, v67
    v_cvt_pk_bf16_f32 v74, v68, v69
    v_cvt_pk_bf16_f32 v75, v70, v71
    ds_write2_b64 v215, v[72:73], v[74:75] offset1:4
    s_waitcnt vmcnt(0) lgkmcnt(0)
    s_barrier
    ds_read_b128 v[88:91], v216 offset:0
    ds_read_b128 v[160:163], v200
    ds_read_b128 v[176:179], v204
    ds_read_b128 v[92:95], v216 offset:64
    ds_read_b128 v[164:167], v201
    ds_read_b128 v[180:183], v205
    ds_read_b128 v[96:99], v216 offset:128
    ds_read_b128 v[168:171], v202
    ds_read_b128 v[184:187], v206
    ds_read_b128 v[100:103], v216 offset:192
    ds_read_b128 v[172:175], v203
    ds_read_b128 v[188:191], v207
    s_mov_b32 s50, 0x3e0293ee
    s_waitcnt lgkmcnt(10)
    v_mfma_f32_16x16x32_bf16 v[64:67], v[88:91], v[160:163], 0
    s_waitcnt lgkmcnt(9)
    v_mfma_f32_16x16x32_bf16 v[68:71], v[88:91], v[176:179], 0
    s_waitcnt lgkmcnt(7)
    v_mfma_f32_16x16x32_bf16 v[64:67], v[92:95], v[164:167], v[64:67]
    s_waitcnt lgkmcnt(6)
    v_mfma_f32_16x16x32_bf16 v[68:71], v[92:95], v[180:183], v[68:71]
    s_waitcnt lgkmcnt(4)
    v_mfma_f32_16x16x32_bf16 v[64:67], v[96:99], v[168:171], v[64:67]
    s_waitcnt lgkmcnt(3)
    v_mfma_f32_16x16x32_bf16 v[68:71], v[96:99], v[184:187], v[68:71]
    s_waitcnt lgkmcnt(1)
    v_mfma_f32_16x16x32_bf16 v[64:67], v[100:103], v[172:175], v[64:67]
    s_waitcnt lgkmcnt(0)
    v_mfma_f32_16x16x32_bf16 v[68:71], v[100:103], v[188:191], v[68:71]
    s_mov_b32 exec_hi, 0
    s_nop 4
    v_mul_f32 v64, s50, v64
    s_nop 0
    v_mul_f32 v68, s50, v68
    v_cvt_pk_bf16_f32 v84, v64, v68
    s_nop 1
    v_cndmask_b32_dpp v80, v84, v82, vcc quad_perm:[0,2,0,2] row_mask:0xf bank_mask:0xf
    v_cndmask_b32_dpp v81, v84, v83, vcc quad_perm:[1,3,1,3] row_mask:0xf bank_mask:0xf
    buffer_store_dwordx2 v[80:81], v217, s[4:7], 0 offen sc1
    s_mov_b32 exec_hi, -1
    s_lshl4_add_u32 s50, s3, s33
    s_lshl3_add_u32 s50, s50, s34
    s_lshl_b32 s50, s50, 14
    s_add_u32 s50, s50, 65536
    v_lshlrev_b32 v58, 7, v1
    buffer_load_dword v59, v58, s[40:43], s50 offen
    s_xor_b32 s50, s50, 8192
    buffer_load_dword v59, v58, s[40:43], s50 offen
    s_cmp_lg_u32 s34, 0
    s_cbranch_scc1 L_b_y
    v_add_u32 v56, 157200, v250
    s_mov_b32 s49, 1
    s_branch L_ln_loop
L_b_y:
    v_and_b32 v56, 3, v1
    v_and_b32 v57, 1, v1
    v_bfe_u32 v53, v1, 2, 2
    v_xor_b32 v52, s34, v53
    v_lshlrev_b32 v52, 5, v52
    v_lshl_add_u32 v52, v56, 3, v52
    v_lshl_add_u32 v52, v53, 8, v52
    v_and_b32 v53, 16, v1
    v_lshl_add_u32 v52, v53, 3, v52
    v_and_b32 v53, 32, v1
    v_lshl_add_u32 v52, v53, 5, v52
    v_add_u32 v8, 43008, v52
    v_bfe_u32 v53, v1, 2, 1
    v_mul_u32_u24 v52, 1160, v53
    s_mul_i32 s50, s33, 72
    s_add_u32 s50, s50, 157200
    v_add_u32 v10, s50, v52
    v_lshl_add_u32 v9, v2, 3, v10
    v_lshl_add_u32 v52, v53, 1, v57
    v_mul_u32_u24 v52, 160, v52
    v_lshl_add_u32 v52, v2, 4, v52
    v_add_u32 v24, 160160, v52
    v_bfe_u32 v52, v1, 2, 2
    v_mul_u32_u24 v52, 6144, v52
    v_lshl_add_u32 v52, v2, 10, v52
    v_lshlrev_b32 v54, 4, v56
    v_add_u32 v52, v54, v52
    s_lshl2_add_u32 s50, s3, s34
    s_mul_i32 s50, s50, 24576
    s_lshl_b32 s51, s33, 6
    s_add_u32 s50, s50, s51
    s_add_u32 s50, s50, 2490368
    v_add_u32 v11, s50, v52
    v_mul_u32_u24 v52, 544, v56
    v_lshl_add_u32 v52, v2, 4, v52
    v_add_u32 v27, 160800, v52
    v_mul_u32_u24 v52, 160, v56
    v_lshl_add_u32 v52, v2, 4, v52
    s_xor_b32 s50, s34, s39
    s_lshr_b32 s50, s50, 1
    s_lshl_b32 s50, s50, 3
    s_and_b32 s51, s34, 1
    s_add_u32 s50, s50, s51
    s_lshl3_add_u32 s50, s50, 160160
    v_add_u32 v23, s50, v52
    v_bfe_u32 v53, v1, 1, 3
    v_lshlrev_b32 v52, 3, v57
    v_and_b32 v54, 2, v1
    v_lshl_add_u32 v52, v54, 5, v52
    v_and_b32 v54, 36, v1
    v_lshl_add_u32 v52, v54, 2, v52
    v_and_b32 v54, 16, v1
    v_lshl_add_u32 v52, v54, 1, v52
    s_mul_i32 s50, s34, 544
    s_add_u32 s50, s50, 160800
    v_add_u32 v26, s50, v52
    v_lshlrev_b32 v52, 4, v57
    v_mov_b32 v54, 0xffff
    v_lshlrev_b32 v54, v52, v54
    v_cmp_eq_u32 vcc, 0, v53
    s_nop 1
    v_cndmask_b32 v28, 0, v54, vcc
    v_cmp_eq_u32 vcc, 1, v53
    s_nop 1
    v_cndmask_b32 v29, 0, v54, vcc
    v_cmp_eq_u32 vcc, 2, v53
    s_nop 1
    v_cndmask_b32 v30, 0, v54, vcc
    v_cmp_eq_u32 vcc, 3, v53
    s_nop 1
    v_cndmask_b32 v31, 0, v54, vcc
    v_lshlrev_b32 v22, 2, v2
    s_lshl2_add_u32 s50, s38, s57
    s_lshl2_add_u32 s50, s50, s34
    s_lshl_b32 s50, s50, 12
    s_add_u32 s50, s50, 393216
    v_add_u32 v20, s50, v3
    s_lshl_b32 s50, s34, 4
    v_and_b32 v52, 31, v1
    v_xor_b32 v52, s50, v52
    s_lshl4_add_u32 s50, s38, 262144
    v_lshl_add_u32 v21, v52, 9, s50
    v_bfe_u32 v52, v1, 3, 2
    v_and_b32 v53, 112, v3
    v_lshl_add_u32 v52, v52, 14, v53
    s_mul_i32 s50, s34, 196608
    s_lshl4_add_u32 s51, s3, s33
    s_lshl_b32 s51, s51, 7
    s_add_u32 s50, s50, s51
    s_add_u32 s50, s50, 4063232
    v_add_u32 v25, s50, v52
    v_lshrrev_b32 v52, 2, v1
    v_bfe_u32 v53, v1, 3, 2
    v_and_b32 v54, 3, v1
    v_lshlrev_b32 v54, 3, v54
    s_movk_i32 s50, 1152
    v_mad_u32_u24 v55, v52, s50, v54
    v_and_b32 v52, 3, v52
    v_mad_u32_u24 v56, v52, s50, v54
    v_add_u32 v56, 36864, v56
    v_lshrrev_b32 v52, 1, v52
    s_mul_i32 s50, s34, 9
    v_add_u32 v54, s50, v2
    v_xor_b32 v54, v54, v52
    v_lshl_add_u32 v16, v54, 5, v56
    v_xor_b32 v54, s50, v53
    v_lshl_add_u32 v12, v54, 5, v55
    s_add_u32 s50, s50, 1
    v_xor_b32 v54, s50, v53
    v_lshl_add_u32 v13, v54, 5, v55
    s_add_u32 s50, s50, 1
    v_xor_b32 v54, s50, v53
    v_lshl_add_u32 v14, v54, 5, v55
    s_add_u32 s50, s50, 1
    v_xor_b32 v54, s50, v53
    v_lshl_add_u32 v15, v54, 5, v55
    v_add_u32 v240, 75776, v12
    v_add_u32 v241, 75776, v13
    v_add_u32 v242, 75776, v14
    v_add_u32 v243, 75776, v15
    s_waitcnt vmcnt(0)
    s_lshl4_add_u32 s50, s3, s33
    s_lshl_b32 s50, s50, 7
    s_add_u32 s50, s50, 196608
    v_mov_b32 v48, s50
    buffer_load_dword v59, v48, s[4:7], 0 offen sc1
L_pg1:
    s_lshl_b32 s51, s34, 10
    s_add_u32 m0, s51, 36864
    s_nop 0
    buffer_load_dwordx4 v239, s[8:11], s45 offen nt lds
    s_mov_b32 m0, 40960
    s_nop 0
    buffer_load_dwordx4 v234, s[8:11], s45 offen nt lds
    s_add_u32 m0, s62, 0
    s_nop 0
    buffer_load_dwordx4 v230, s[8:11], s63 offen nt lds
    s_add_u32 m0, s62, 0
    s_nop 0
    buffer_load_dwordx4 v231, s[8:11], s63 offen offset:1024 nt lds
    s_add_u32 m0, s62, 0
    s_nop 0
    buffer_load_dwordx4 v232, s[8:11], s63 offen offset:2048 nt lds
    s_add_u32 m0, s62, 0
    s_nop 0
    buffer_load_dwordx4 v233, s[8:11], s63 offen offset:3072 nt lds
    s_add_u32 m0, s62, 4096
    s_nop 0
    buffer_load_dwordx4 v234, s[8:11], s63 offen nt lds
    s_add_u32 m0, s62, 4096
    s_nop 0
    buffer_load_dwordx4 v235, s[8:11], s63 offen offset:1024 nt lds
    s_add_u32 m0, s62, 4096
    s_nop 0
    buffer_load_dwordx4 v236, s[8:11], s63 offen offset:2048 nt lds
    s_add_u32 m0, s62, 4096
    s_nop 0
    buffer_load_dwordx4 v237, s[8:11], s63 offen offset:3072 nt lds
    s_add_u32 m0, s62, 8192
    s_nop 0
    buffer_load_dwordx4 v238, s[8:11], s63 offen nt lds
    s_add_u32 m0, s62, 75776
    s_nop 0
    buffer_load_dwordx4 v220, s[16:19], s58 offen  lds
    s_add_u32 m0, s62, 75776
    s_nop 0
    buffer_load_dwordx4 v221, s[16:19], s58 offen offset:1024  lds
    s_add_u32 m0, s62, 75776
    s_nop 0
    buffer_load_dwordx4 v222, s[16:19], s58 offen offset:2048  lds
    s_add_u32 m0, s62, 75776
    s_nop 0
    buffer_load_dwordx4 v223, s[16:19], s58 offen offset:3072  lds
    s_add_u32 m0, s62, 79872
    s_nop 0
    buffer_load_dwordx4 v224, s[16:19], s58 offen  lds
    s_add_u32 m0, s62, 79872
    s_nop 0
    buffer_load_dwordx4 v225, s[16:19], s58 offen offset:1024  lds
    s_add_u32 m0, s62, 79872
    s_nop 0
    buffer_load_dwordx4 v226, s[16:19], s58 offen offset:2048  lds
    s_add_u32 m0, s62, 79872
    s_nop 0
    buffer_load_dwordx4 v227, s[16:19], s58 offen offset:3072  lds
    s_branch L_pg2
.p2align 12
L_pg2:
    s_waitcnt vmcnt(8) lgkmcnt(0)
    s_barrier
    ds_read2_b64 v[192:195], v9 offset1:4
    s_add_u32 m0, s62, 83968
    s_nop 0
    buffer_load_dwordx4 v228, s[16:19], s58 offen  lds
    ds_read_b64 v[196:197], v10 offset:64
    ds_read_b64_tr_b16 v[64:65], v12 offset:0
    ds_read_b64_tr_b16 v[66:67], v12 offset:18432
    ds_read_b64_tr_b16 v[70:71], v13 offset:0
    ds_read_b64_tr_b16 v[72:73], v13 offset:18432
    ds_read_b64_tr_b16 v[76:77], v14 offset:0
    ds_read_b64_tr_b16 v[78:79], v14 offset:18432
    ds_read_b64_tr_b16 v[68:69], v16 offset:0
    ds_read_b64_tr_b16 v[74:75], v16 offset:128
    ds_read_b64_tr_b16 v[80:81], v16 offset:256
    ds_read_b64_tr_b16 v[82:83], v15 offset:0
    ds_read_b64_tr_b16 v[84:85], v15 offset:18432
    v_and_b32 v198, 3, v1
    v_cmp_eq_u32 vcc, v198, v2
    s_mov_b32 s50, 2048
    s_mov_b32 s61, 4096
    v_mov_b32 v203, s36
    v_mov_b32 v207, s36
    v_mov_b32 v211, s36
    s_waitcnt lgkmcnt(11)
    v_cndmask_b32 v196, 0, v196, vcc
    v_cndmask_b32 v197, 0, v197, vcc
    s_waitcnt lgkmcnt(9)
    v_mfma_f32_16x16x32_bf16 v[120:123], v[192:195], v[64:67], 0
    ds_read_b64_tr_b16 v[88:89], v12 offset:128
    ds_read_b64_tr_b16 v[90:91], v12 offset:18560
    s_waitcnt lgkmcnt(9)
    v_mfma_f32_16x16x32_bf16 v[124:127], v[192:195], v[70:73], 0
    ds_read_b64_tr_b16 v[94:95], v13 offset:128
    ds_read_b64_tr_b16 v[96:97], v13 offset:18560
    s_waitcnt lgkmcnt(9)
    v_mfma_f32_16x16x32_bf16 v[128:131], v[192:195], v[76:79], 0
    ds_read_b64_tr_b16 v[100:101], v14 offset:128
    ds_read_b64_tr_b16 v[102:103], v14 offset:18560
    s_waitcnt lgkmcnt(10)
    v_mfma_f32_16x16x16_bf16 v[156:159], v[196:197], v[68:69], 0
    ds_read_b64_tr_b16 v[106:107], v15 offset:128
    ds_read_b64_tr_b16 v[108:109], v15 offset:18560
    s_waitcnt lgkmcnt(11)
    v_mfma_f32_16x16x16_bf16 v[160:163], v[196:197], v[74:75], 0
    ds_read_b64_tr_b16 v[112:113], v12 offset:256
    ds_read_b64_tr_b16 v[114:115], v12 offset:18688
    s_waitcnt lgkmcnt(12)
    v_mfma_f32_16x16x16_bf16 v[164:167], v[196:197], v[80:81], 0
    s_waitcnt lgkmcnt(4)
    s_mov_b32 exec_hi, 0
    v_mfma_f32_16x16x32_bf16 v[132:135], v[192:195], v[82:85], 0
    v_mfma_f32_16x16x32_bf16 v[136:139], v[192:195], v[88:91], 0
    v_mfma_f32_16x16x32_bf16 v[140:143], v[192:195], v[94:97], 0
    v_mfma_f32_16x16x32_bf16 v[144:147], v[192:195], v[100:103], 0
    v_add_f32 v200, v120, v156
    v_add_f32 v201, v124, v157
    v_add_f32 v202, v128, v158
    buffer_store_dwordx4 v[200:203], v11, s[4:7], 0 offen sc1
    s_waitcnt lgkmcnt(0)
    v_mfma_f32_16x16x32_bf16 v[148:151], v[192:195], v[106:109], 0
    v_mfma_f32_16x16x32_bf16 v[152:155], v[192:195], v[112:115], 0
    v_add_f32 v204, v132, v159
    v_add_f32 v205, v136, v160
    v_add_f32 v206, v140, v161
    buffer_store_dwordx4 v[204:207], v11, s[4:7], s50 offen sc1
    v_add_f32 v208, v144, v162
    s_nop 1
    v_add_f32 v209, v148, v163
    v_add_f32 v210, v152, v164
    buffer_store_dwordx4 v[208:211], v11, s[4:7], s61 offen sc1
    s_mov_b32 exec_hi, -1
    s_add_u32 m0, s62, 112640
    s_nop 0
    buffer_load_dwordx4 v220, s[16:19], s59 offen nt lds
    s_add_u32 m0, s62, 112640
    s_nop 0
    buffer_load_dwordx4 v221, s[16:19], s59 offen offset:1024 nt lds
    s_add_u32 m0, s62, 112640
    s_nop 0
    buffer_load_dwordx4 v222, s[16:19], s59 offen offset:2048 nt lds
    s_add_u32 m0, s62, 112640
    s_nop 0
    buffer_load_dwordx4 v223, s[16:19], s59 offen offset:3072 nt lds
    s_add_u32 m0, s62, 116736
    s_nop 0
    buffer_load_dwordx4 v224, s[16:19], s59 offen nt lds
    s_add_u32 m0, s62, 116736
    s_nop 0
    buffer_load_dwordx4 v225, s[16:19], s59 offen offset:1024 nt lds
    s_add_u32 m0, s62, 116736
    s_nop 0
    buffer_load_dwordx4 v226, s[16:19], s59 offen offset:2048 nt lds
    s_add_u32 m0, s62, 116736
    s_nop 0
    buffer_load_dwordx4 v227, s[16:19], s59 offen offset:3072 nt lds
    s_add_u32 m0, s62, 120832
    s_nop 0
    buffer_load_dwordx4 v228, s[16:19], s59 offen nt lds
    s_lshl4_add_u32 s50, s3, s33
    s_lshl_b32 s50, s50, 7
    s_add_u32 s50, s50, 196608
    v_mov_b32 v48, s50
    s_add_u32 m0, s48, 43008
    s_mov_b32 s52, 0
    buffer_load_dwordx4 v218, s[24:27], s52 offen nt lds
    s_add_u32 m0, s48, 47104
    s_mov_b32 s52, 262144
    buffer_load_dwordx4 v218, s[24:27], s52 offen nt lds
    s_add_u32 m0, s48, 51200
    s_mov_b32 s52, 524288
    buffer_load_dwordx4 v218, s[24:27], s52 offen nt lds
    s_add_u32 m0, s48, 55296
    s_mov_b32 s52, 786432
    buffer_load_dwordx4 v218, s[24:27], s52 offen nt lds
    s_add_u32 m0, s48, 59392
    s_mov_b32 s52, 1048576
    buffer_load_dwordx4 v218, s[24:27], s52 offen nt lds
    s_add_u32 m0, s48, 63488
    s_mov_b32 s52, 1310720
    buffer_load_dwordx4 v218, s[24:27], s52 offen nt lds
    s_add_u32 m0, s48, 67584
    s_mov_b32 s52, 1572864
    buffer_load_dwordx4 v218, s[24:27], s52 offen nt lds
    s_add_u32 m0, s48, 71680
    s_mov_b32 s52, 1835008
    buffer_load_dwordx4 v218, s[24:27], s52 offen nt lds
L_pg3:
    s_mov_b32 s54, 0
    s_movk_i32 s53, 16384
    v_mov_b32 v203, s36
    v_mov_b32 v207, s36
    v_mov_b32 v211, s36
    s_waitcnt vmcnt(8)
    s_barrier
    ds_read_b64_tr_b16 a[68:69], v240 offset:36864
    ds_read_b64_tr_b16 a[70:71], v240 offset:55296
    ds_read_b64_tr_b16 a[72:73], v241 offset:36864
    ds_read_b64_tr_b16 a[74:75], v241 offset:55296
    ds_read_b64_tr_b16 a[76:77], v242 offset:36864
    ds_read_b64_tr_b16 a[78:79], v242 offset:55296
    ds_read_b64_tr_b16 a[80:81], v243 offset:36864
    ds_read_b64_tr_b16 a[82:83], v243 offset:55296
    ds_read_b64_tr_b16 a[84:85], v240 offset:36992
    ds_read_b64_tr_b16 a[86:87], v240 offset:55424
    ds_read_b64_tr_b16 a[88:89], v241 offset:36992
    ds_read_b64_tr_b16 a[90:91], v241 offset:55424
    ds_read_b64_tr_b16 a[92:93], v242 offset:36992
    ds_read_b64_tr_b16 a[94:95], v242 offset:55424
    ds_read_b64_tr_b16 a[96:97], v243 offset:36992
    ds_read_b64_tr_b16 a[98:99], v243 offset:55424
    ds_read_b64_tr_b16 a[100:101], v240 offset:37120
    ds_read_b64_tr_b16 a[102:103], v240 offset:55552
    ds_read_b64_tr_b16 a[32:33], v240 offset:0
    ds_read_b64_tr_b16 a[34:35], v240 offset:18432
    ds_read_b64_tr_b16 a[36:37], v241 offset:0
    ds_read_b64_tr_b16 a[38:39], v241 offset:18432
    ds_read_b64_tr_b16 a[40:41], v242 offset:0
    ds_read_b64_tr_b16 a[42:43], v242 offset:18432
    ds_read_b64_tr_b16 a[44:45], v243 offset:0
    ds_read_b64_tr_b16 a[46:47], v243 offset:18432
    ds_read_b64_tr_b16 a[48:49], v240 offset:128
    ds_read_b64_tr_b16 a[50:51], v240 offset:18560
    ds_read_b64_tr_b16 a[52:53], v241 offset:128
    ds_read_b64_tr_b16 a[54:55], v241 offset:18560
    ds_read_b64_tr_b16 a[56:57], v242 offset:128
    ds_read_b64_tr_b16 a[58:59], v242 offset:18560
    ds_read_b64_tr_b16 a[60:61], v243 offset:128
    ds_read_b64_tr_b16 a[62:63], v243 offset:18560
    ds_read_b64_tr_b16 a[64:65], v240 offset:256
    ds_read_b64_tr_b16 a[66:67], v240 offset:18688
    s_waitcnt vmcnt(0)
    s_barrier
    ds_read_b64_tr_b16 a[0:1], v8 offset:0
    ds_read_b64_tr_b16 a[2:3], v8 offset:2048
    ds_read_b64_tr_b16 a[4:5], v8 offset:4096
    ds_read_b64_tr_b16 a[6:7], v8 offset:6144
    ds_read_b64_tr_b16 a[8:9], v8 offset:8192
    ds_read_b64_tr_b16 a[10:11], v8 offset:10240
    ds_read_b64_tr_b16 a[12:13], v8 offset:12288
    ds_read_b64_tr_b16 a[14:15], v8 offset:14336
    ds_read_b64_tr_b16 a[16:17], v8 offset:16384
    ds_read_b64_tr_b16 a[18:19], v8 offset:18432
    ds_read_b64_tr_b16 a[20:21], v8 offset:20480
    ds_read_b64_tr_b16 a[22:23], v8 offset:22528
    ds_read_b64_tr_b16 a[24:25], v8 offset:24576
    ds_read_b64_tr_b16 a[26:27], v8 offset:26624
    ds_read_b64_tr_b16 a[28:29], v8 offset:28672
    ds_read_b64_tr_b16 a[30:31], v8 offset:30720
L_fl:
    buffer_load_dwordx4 v[44:47], v21, s[4:7], 0 offen sc1
    s_add_u32 s54, s54, 1
    s_cmp_gt_u32 s54, 131072
    s_waitcnt vmcnt(0)
    s_cbranch_scc1 L_h3
    v_cmp_ne_u64 vcc, s[36:37], v[46:47]
    s_cbranch_vccnz L_fl
L_h3:
    buffer_load_dwordx4 v[64:67], v20, s[4:7], 0 offen offset:0 sc1
    buffer_load_dwordx4 v[68:71], v20, s[4:7], 0 offen offset:1024 sc1
    buffer_load_dwordx4 v[72:75], v20, s[4:7], 0 offen offset:2048 sc1
    buffer_load_dwordx4 v[76:79], v20, s[4:7], 0 offen offset:3072 sc1
    buffer_load_dwordx4 v[80:83], v20, s[4:7], s53 offen offset:0 sc1
    buffer_load_dwordx4 v[84:87], v20, s[4:7], s53 offen offset:1024 sc1
    buffer_load_dwordx4 v[88:91], v20, s[4:7], s53 offen offset:2048 sc1
    buffer_load_dwordx4 v[92:95], v20, s[4:7], s53 offen offset:3072 sc1
    v_mov_b32 v52, v44
    s_nop 1
    v_max_f32_dpp v52, v52, v52 row_ror:8 row_mask:0xf bank_mask:0xf
    s_nop 1
    v_max_f32_dpp v52, v52, v52 row_ror:4 row_mask:0xf bank_mask:0xf
    s_nop 1
    v_max_f32_dpp v52, v52, v52 row_ror:2 row_mask:0xf bank_mask:0xf
    s_nop 1
    v_max_f32_dpp v52, v52, v52 row_ror:1 row_mask:0xf bank_mask:0xf
    v_mov_b32 v53, v52
    s_nop 1
    v_permlane16_swap_b32 v52, v53
    v_max_f32 v52, v52, v53
    v_sub_f32 v52, v44, v52
    v_exp_f32 v52, v52
    s_nop 0
    v_mul_f32 v53, v52, v45
    s_nop 1
    v_add_f32_dpp v53, v53, v53 row_ror:8 row_mask:0xf bank_mask:0xf
    s_nop 1
    v_add_f32_dpp v53, v53, v53 row_ror:4 row_mask:0xf bank_mask:0xf
    s_nop 1
    v_add_f32_dpp v53, v53, v53 row_ror:2 row_mask:0xf bank_mask:0xf
    s_nop 1
    v_add_f32_dpp v53, v53, v53 row_ror:1 row_mask:0xf bank_mask:0xf
    v_mov_b32 v54, v53
    s_nop 1
    v_permlane16_swap_b32 v53, v54
    v_add_f32 v53, v53, v54
    v_rcp_f32 v53, v53
    v_mul_f32 v52, 0x3f805879, v52
    v_mul_f32 v52, v52, v53
    v_cvt_pk_bf16_f32 v52, v52, v52
    s_waitcnt lgkmcnt(0)
    ds_bpermute_b32 v32, v22, v52 offset:0
    ds_bpermute_b32 v33, v22, v52 offset:16
    ds_bpermute_b32 v34, v22, v52 offset:32
    ds_bpermute_b32 v35, v22, v52 offset:48
    s_waitcnt lgkmcnt(3)
    v_and_b32 v128, v32, v28
    v_and_b32 v129, v32, v29
    v_and_b32 v130, v32, v30
    v_and_b32 v131, v32, v31
    s_waitcnt lgkmcnt(2)
    v_and_b32 v132, v33, v28
    v_and_b32 v133, v33, v29
    v_and_b32 v134, v33, v30
    v_and_b32 v135, v33, v31
    s_waitcnt lgkmcnt(1)
    v_and_b32 v136, v34, v28
    v_and_b32 v137, v34, v29
    v_and_b32 v138, v34, v30
    v_and_b32 v139, v34, v31
    s_waitcnt lgkmcnt(0)
    v_and_b32 v140, v35, v28
    v_and_b32 v141, v35, v29
    v_and_b32 v142, v35, v30
    v_and_b32 v143, v35, v31
    s_and_b32 s51, s36, 1
    s_mul_i32 s51, s51, 0x00010001
L_r1:
    v_mov_b32 v42, 0
    s_waitcnt vmcnt(7)
    v_xor_b32 v64, s51, v64
    v_xor_b32 v65, s51, v65
    v_xor_b32 v66, s51, v66
    v_xor_b32 v67, s51, v67
    v_or3_b32 v42, v42, v64, v65
    v_or3_b32 v42, v42, v66, v67
    v_mfma_f32_16x16x32_bf16 v[52:55], v[64:67], v[128:131], 0
    s_waitcnt vmcnt(6)
    v_xor_b32 v68, s51, v68
    v_xor_b32 v69, s51, v69
    v_xor_b32 v70, s51, v70
    v_xor_b32 v71, s51, v71
    v_or3_b32 v42, v42, v68, v69
    v_or3_b32 v42, v42, v70, v71
    v_mfma_f32_16x16x32_bf16 v[52:55], v[68:71], v[132:135], v[52:55]
    s_waitcnt vmcnt(5)
    v_xor_b32 v72, s51, v72
    v_xor_b32 v73, s51, v73
    v_xor_b32 v74, s51, v74
    v_xor_b32 v75, s51, v75
    v_or3_b32 v42, v42, v72, v73
    v_or3_b32 v42, v42, v74, v75
    v_mfma_f32_16x16x32_bf16 v[52:55], v[72:75], v[136:139], v[52:55]
    s_waitcnt vmcnt(4)
    v_xor_b32 v76, s51, v76
    v_xor_b32 v77, s51, v77
    v_xor_b32 v78, s51, v78
    v_xor_b32 v79, s51, v79
    v_or3_b32 v42, v42, v76, v77
    v_or3_b32 v42, v42, v78, v79
    v_mfma_f32_16x16x32_bf16 v[52:55], v[76:79], v[140:143], v[52:55]
    s_waitcnt vmcnt(3)
    v_xor_b32 v80, s51, v80
    v_xor_b32 v81, s51, v81
    v_xor_b32 v82, s51, v82
    v_xor_b32 v83, s51, v83
    v_or3_b32 v42, v42, v80, v81
    v_or3_b32 v42, v42, v82, v83
    v_mfma_f32_16x16x32_bf16 v[56:59], v[80:83], v[128:131], 0
    s_waitcnt vmcnt(2)
    v_xor_b32 v84, s51, v84
    v_xor_b32 v85, s51, v85
    v_xor_b32 v86, s51, v86
    v_xor_b32 v87, s51, v87
    v_or3_b32 v42, v42, v84, v85
    v_or3_b32 v42, v42, v86, v87
    v_mfma_f32_16x16x32_bf16 v[56:59], v[84:87], v[132:135], v[56:59]
    s_waitcnt vmcnt(1)
    v_xor_b32 v88, s51, v88
    v_xor_b32 v89, s51, v89
    v_xor_b32 v90, s51, v90
    v_xor_b32 v91, s51, v91
    v_or3_b32 v42, v42, v88, v89
    v_or3_b32 v42, v42, v90, v91
    v_mfma_f32_16x16x32_bf16 v[56:59], v[88:91], v[136:139], v[56:59]
    s_waitcnt vmcnt(0)
    v_xor_b32 v92, s51, v92
    v_xor_b32 v93, s51, v93
    v_xor_b32 v94, s51, v94
    v_xor_b32 v95, s51, v95
    v_or3_b32 v42, v42, v92, v93
    v_or3_b32 v42, v42, v94, v95
    v_mfma_f32_16x16x32_bf16 v[56:59], v[92:95], v[140:143], v[56:59]
    v_and_b32 v42, 0x00010001, v42
    v_cmp_ne_u32 vcc, 0, v42
    s_cbranch_vccnz L_r1x
L_r1k:
    s_mov_b32 exec_lo, 0x00ff00ff
    s_mov_b32 exec_hi, 0x00ff00ff
    v_cvt_pk_bf16_f32 v60, v52, v53
    v_cvt_pk_bf16_f32 v61, v54, v55
    s_nop 0
    v_cvt_pk_bf16_f32 v62, v56, v57
    v_cvt_pk_bf16_f32 v63, v58, v59
    ds_write2_b64 v26, v[60:61], v[62:63] offset1:32
    s_mov_b64 exec, -1
    s_waitcnt lgkmcnt(0)
    s_barrier
    ds_read_b128 v[64:67], v27 offset:0
    ds_read_b128 v[68:71], v27 offset:64
    ds_read_b128 v[72:75], v27 offset:128
    ds_read_b128 v[76:79], v27 offset:192
    ds_read_b128 v[80:83], v27 offset:256
    ds_read_b128 v[84:87], v27 offset:320
    ds_read_b128 v[88:91], v27 offset:384
    ds_read_b128 v[92:95], v27 offset:448
    s_cmp_lg_u32 s34, 0
    s_cbranch_scc1 L_nohu
    s_mov_b64 exec, 1
    buffer_store_dword v203, v48, s[4:7], 0 offen sc1
    s_mov_b64 exec, -1
L_nohu:
    s_waitcnt lgkmcnt(7)
    v_mfma_f32_16x16x32_bf16 v[52:55], a[0:3], v[64:67], 0
    s_waitcnt lgkmcnt(6)
    v_mfma_f32_16x16x32_bf16 v[52:55], a[4:7], v[68:71], v[52:55]
    s_waitcnt lgkmcnt(5)
    v_mfma_f32_16x16x32_bf16 v[52:55], a[8:11], v[72:75], v[52:55]
    s_waitcnt lgkmcnt(4)
    v_mfma_f32_16x16x32_bf16 v[52:55], a[12:15], v[76:79], v[52:55]
    s_waitcnt lgkmcnt(3)
    v_mfma_f32_16x16x32_bf16 v[52:55], a[16:19], v[80:83], v[52:55]
    s_waitcnt lgkmcnt(2)
    v_mfma_f32_16x16x32_bf16 v[52:55], a[20:23], v[84:87], v[52:55]
    s_waitcnt lgkmcnt(1)
    v_mfma_f32_16x16x32_bf16 v[52:55], a[24:27], v[88:91], v[52:55]
    s_waitcnt lgkmcnt(0)
    v_mfma_f32_16x16x32_bf16 v[52:55], a[28:31], v[92:95], v[52:55]
    s_nop 7
    v_cvt_pk_bf16_f32 v60, v52, v53
    v_cvt_pk_bf16_f32 v61, v54, v55
    ds_write_b64 v23, v[60:61]
    s_waitcnt lgkmcnt(0)
    s_barrier
    ds_read_b128 v[96:99], v24 offset:0
    ds_read_b128 v[100:103], v24 offset:64
    s_mov_b32 s50, 0x10000
    s_mov_b32 s51, 0x20000
    s_mov_b32 exec_hi, 0
    s_waitcnt lgkmcnt(1)
    v_mfma_f32_16x16x32_bf16 v[160:163], v[96:99], a[32:35], 0
    s_waitcnt lgkmcnt(0)
    v_mfma_f32_16x16x32_bf16 v[160:163], v[100:103], a[68:71], v[160:163]
    v_mfma_f32_16x16x32_bf16 v[164:167], v[96:99], a[36:39], 0
    v_mfma_f32_16x16x32_bf16 v[164:167], v[100:103], a[72:75], v[164:167]
    v_mfma_f32_16x16x32_bf16 v[168:171], v[96:99], a[40:43], 0
    v_mfma_f32_16x16x32_bf16 v[168:171], v[100:103], a[76:79], v[168:171]
    v_mfma_f32_16x16x32_bf16 v[172:175], v[96:99], a[44:47], 0
    v_mfma_f32_16x16x32_bf16 v[172:175], v[100:103], a[80:83], v[172:175]
    v_mfma_f32_16x16x32_bf16 v[176:179], v[96:99], a[48:51], 0
    v_mfma_f32_16x16x32_bf16 v[176:179], v[100:103], a[84:87], v[176:179]
    v_mfma_f32_16x16x32_bf16 v[180:183], v[96:99], a[52:55], 0
    v_mfma_f32_16x16x32_bf16 v[180:183], v[100:103], a[88:91], v[180:183]
    v_add_f32 v200, v160, v161
    v_add_f32 v201, v164, v165
    v_add_f32 v202, v168, v169
    buffer_store_dwordx4 v[200:203], v25, s[4:7], 0 offen sc1
    v_mfma_f32_16x16x32_bf16 v[184:187], v[96:99], a[56:59], 0
    v_mfma_f32_16x16x32_bf16 v[184:187], v[100:103], a[92:95], v[184:187]
    v_mfma_f32_16x16x32_bf16 v[188:191], v[96:99], a[60:63], 0
    v_mfma_f32_16x16x32_bf16 v[188:191], v[100:103], a[96:99], v[188:191]
    v_mfma_f32_16x16x32_bf16 v[192:195], v[96:99], a[64:67], 0
    v_mfma_f32_16x16x32_bf16 v[192:195], v[100:103], a[100:103], v[192:195]
    v_add_f32 v204, v172, v173
    v_add_f32 v205, v176, v177
    v_add_f32 v206, v180, v181
    buffer_store_dwordx4 v[204:207], v25, s[4:7], s50 offen sc1
    v_add_f32 v208, v184, v185
    s_nop 0
    v_add_f32 v209, v188, v189
    s_nop 0
    v_add_f32 v210, v192, v193
    buffer_store_dwordx4 v[208:211], v25, s[4:7], s51 offen sc1
    s_mov_b32 exec_hi, -1
    s_branch L_fin
L_r1x:
    s_add_u32 s54, s54, 1
    s_cmp_gt_u32 s54, 131072
    s_cbranch_scc1 L_r1k
    s_nop 7
    buffer_load_dwordx4 v[64:67], v20, s[4:7], 0 offen offset:0 sc1
    buffer_load_dwordx4 v[68:71], v20, s[4:7], 0 offen offset:1024 sc1
    buffer_load_dwordx4 v[72:75], v20, s[4:7], 0 offen offset:2048 sc1
    buffer_load_dwordx4 v[76:79], v20, s[4:7], 0 offen offset:3072 sc1
    buffer_load_dwordx4 v[80:83], v20, s[4:7], s53 offen offset:0 sc1
    buffer_load_dwordx4 v[84:87], v20, s[4:7], s53 offen offset:1024 sc1
    buffer_load_dwordx4 v[88:91], v20, s[4:7], s53 offen offset:2048 sc1
    buffer_load_dwordx4 v[92:95], v20, s[4:7], s53 offen offset:3072 sc1
    s_branch L_r1
.p2align 12
L_pg4:
L_a0:
    s_lshr_b32 s63, s33, 1
    s_lshl3_add_u32 s63, s3, s63
    s_and_b32 s49, s33, 1
    s_lshl1_add_u32 s50, s63, s49
    s_lshl3_add_u32 s50, s50, s34
    s_lshl_b32 s47, s50, 14
    s_lshl_b32 s46, s34, 15
    s_mov_b32 s10, 16777216
    s_mov_b32 s11, 0x20000
    v_lshrrev_b32 v4, 3, v0
    v_and_b32 v5, 7, v0
    v_lshlrev_b32 v5, 7, v5
    v_lshl_add_u32 v4, v4, 13, v5
    s_lshl_b32 s51, s3, 10
    s_lshl_b32 s53, s33, 18
    s_add_u32 s53, s53, s51
    s_cmp_lg_u32 s34, 0
    s_cbranch_scc1 L_a_nt0
    s_and_b32 s50, s33, 7
    s_cmp_ge_u32 s33, 8
    s_cselect_b32 s52, 104, 32
    s_add_u32 s50, s50, s52
    s_lshl_b32 s50, s50, 15
    v_add_u32 v7, s50, v4
    s_add_u32 s50, s33, 4
    s_lshr_b32 s50, s50, 3
    s_add_u32 s50, s50, s33
    s_lshl_b32 s50, s50, 18
    s_add_u32 s50, s50, 4294705536
    v_lshl_add_u32 v24, v1, 13, s50
    s_lshr_b32 s50, s33, 2
    s_mul_i32 s50, s50, 9
    s_add_u32 s50, s50, 1
    s_and_b32 s50, s50, -2
    s_add_u32 s50, s50, s39
    s_add_u32 s50, s50, 3
    s_lshl_b32 s50, s50, 17
    s_add_u32 s50, s50, 256
    v_lshrrev_b32 v24, 1, v1
    v_and_b32 v25, 1, v1
    v_lshl_add_u32 v24, v24, 13, s50
    v_lshl_add_u32 v24, v25, 7, v24
    v_cmp_gt_u32 vcc, 32, v1
    s_nop 1
    v_cndmask_b32 v7, v24, v7, vcc
    s_waitcnt lgkmcnt(0)
    buffer_load_dword v5, v7, s[20:23], s51 offen
L_a_nt0:
    s_waitcnt lgkmcnt(0)
    v_xor_b32 v8, 0, v3
    v_xor_b32 v9, 32, v3
    v_xor_b32 v10, 64, v3
    v_xor_b32 v11, 96, v3
    v_xor_b32 v12, 4224, v3
    v_xor_b32 v13, 4256, v3
    v_xor_b32 v14, 4288, v3
    v_xor_b32 v15, 4320, v3
    v_xor_b32 v16, 8336, v3
    v_xor_b32 v17, 8368, v3
    v_xor_b32 v18, 8400, v3
    v_xor_b32 v19, 8432, v3
    v_xor_b32 v20, 12304, v3
    v_xor_b32 v21, 12336, v3
    v_xor_b32 v22, 12368, v3
    v_xor_b32 v23, 12400, v3
    s_load_dword s35, s[4:5], 0
    s_load_dwordx2 s[16:17], s[0:1], 72
    s_load_dwordx2 s[24:25], s[0:1], 64
    s_load_dwordx2 s[40:41], s[0:1], 88
    v_and_b32 v54, 15, v1
    v_lshrrev_b32 v52, 3, v54
    v_lshlrev_b32 v7, 2, v52
    v_xor_b32 v7, v7, v54
    v_and_b32 v7, 7, v7
    v_lshl_or_b32 v7, v7, 1, v52
    v_xor_b32 v7, v7, v2
    v_lshlrev_b32 v7, 4, v7
    v_lshl_add_u32 v7, v54, 10, v7
    v_add_u32 v24, s46, v7
    v_xor_b32 v25, 64, v24
    v_xor_b32 v26, 128, v24
    v_xor_b32 v27, 192, v24
    v_lshrrev_b32 v53, 2, v1
    v_lshrrev_b32 v52, 5, v1
    v_lshlrev_b32 v7, 2, v52
    v_xor_b32 v7, v7, v53
    v_and_b32 v7, 7, v7
    v_lshl_or_b32 v7, v7, 1, v52
    v_lshlrev_b32 v7, 1, v7
    v_and_b32 v52, 3, v1
    v_xor_b32 v7, v7, v52
    v_lshlrev_b32 v7, 3, v7
    v_lshl_add_u32 v7, v53, 10, v7
    s_lshl_b32 s50, s34, 8
    v_add_u32 v28, s50, v7
    v_xor_b32 v29, 32, v28
    v_xor_b32 v30, 64, v28
    v_xor_b32 v31, 96, v28
    v_xor_b32 v32, 128, v28
    v_xor_b32 v33, 160, v28
    v_xor_b32 v34, 192, v28
    v_xor_b32 v35, 224, v28
    v_add_u32 v36, 0x10000, v28
    v_add_u32 v37, 0x10000, v29
    v_add_u32 v38, 0x10000, v30
    v_add_u32 v39, 0x10000, v31
    v_add_u32 v40, 0x10000, v32
    v_add_u32 v41, 0x10000, v33
    v_add_u32 v42, 0x10000, v34
    v_add_u32 v43, 0x10000, v35
    v_lshrrev_b32 v52, 2, v54
    v_lshlrev_b32 v52, 1, v52
    s_movk_i32 s51, 0x78
    v_bfe_u32 v52, s51, v52, 2
    v_bfe_u32 v53, v1, 1, 1
    v_lshl_add_u32 v52, v52, 1, v53
    v_lshlrev_b32 v52, 4, v52
    v_lshl_add_u32 v52, v54, 7, v52
    v_add_u32 v52, 131072, v52
    v_xor_b32 v47, 16, v52
    v_lshlrev_b32 v53, 5, v2
    v_xor_b32 v51, v52, v53
    s_lshl_b32 s50, s34, 13
    v_xad_u32 v244, v51, 16, s50
    s_add_u32 s48, s50, 131072
    s_lshl_b32 s50, s34, 2
    v_add_u32 v46, s50, v47
    v_and_b32 v52, 32, v1
    v_and_b32 v53, 16, v1
    v_lshl_add_u32 v52, v52, 1, v53
    v_xor_b32 v52, v52, v3
    s_lshr_b32 s50, s63, 5
    s_lshl1_add_u32 s50, s50, s49
    s_lshl2_add_u32 s50, s50, s34
    s_lshl_b32 s50, s50, 13
    s_add_u32 s50, s50, 4096
    v_add_u32 v44, s50, v52
    v_xor_b32 v245, 96, v44
    v_add_u32 v45, 139264, v3
    s_lshl_b32 s51, s34, 10
    v_add_u32 v50, s51, v45
    v_lshlrev_b32 v52, 4, v54
    s_lshl1_add_u32 s51, s63, s49
    s_lshl_b32 s51, s51, 8
    s_add_u32 s51, s51, 262144
    v_add_u32 v49, s51, v52
    v_lshlrev_b32 v52, 3, v54
    v_lshl_add_u32 v52, v2, 18, v52
    s_lshl_b32 s50, s49, 6
    s_add_u32 s50, s50, s34
    s_lshl_b32 s50, s50, 6
    s_add_u32 s50, s50, s63
    s_lshl_b32 s50, s50, 8
    s_add_u32 s50, s50, 393216
    v_add_u32 v48, s50, v52
    s_lshr_b32 s50, s33, 2
    s_mul_i32 s50, s50, 144
    s_mul_i32 s51, s3, 576
    s_add_u32 s50, s50, s51
    s_lshl2_add_u32 s58, s39, s50
    s_mul_i32 s59, s58, 1152
    v_lshlrev_b32 v227, 4, v2
    s_xor_b32 s45, s47, 131072
    s_mul_i32 s62, s34, 9216
    s_mov_b32 s6, 268435456
    s_mov_b32 s7, 0x20000
    s_mov_b32 s18, 5308416
    s_mov_b32 s19, 0x20000
    s_mov_b32 s26, 9216
    s_mov_b32 s27, 0x20000
    s_mov_b32 s42, 2304
    s_mov_b32 s43, 0x20000
    v_lshrrev_b32 v52, 3, v1
    v_mul_u32_u24 v52, 57, v52
    s_mov_b32 s50, 13824
    v_add_u32 v54, 0, v52
    v_lshrrev_b32 v55, 5, v54
    v_and_b32 v55, 0x60, v55
    v_lshrrev_b32 v54, 11, v54
    v_xor_b32 v55, v55, v3
    v_mad_u32_u24 v248, v54, s50, v55
    v_add_u32 v54, 456, v52
    v_lshrrev_b32 v55, 5, v54
    v_and_b32 v55, 0x60, v55
    v_lshrrev_b32 v54, 11, v54
    v_xor_b32 v55, v55, v3
    v_mad_u32_u24 v249, v54, s50, v55
    v_add_u32 v54, 912, v52
    v_lshrrev_b32 v55, 5, v54
    v_and_b32 v55, 0x60, v55
    v_lshrrev_b32 v54, 11, v54
    v_xor_b32 v55, v55, v3
    v_mad_u32_u24 v250, v54, s50, v55
    v_add_u32 v54, 1368, v52
    v_lshrrev_b32 v55, 5, v54
    v_and_b32 v55, 0x60, v55
    v_lshrrev_b32 v54, 11, v54
    v_xor_b32 v55, v55, v3
    v_mad_u32_u24 v251, v54, s50, v55
    v_add_u32 v54, 1824, v52
    v_lshrrev_b32 v55, 5, v54
    v_and_b32 v55, 0x60, v55
    v_lshrrev_b32 v54, 11, v54
    s_movk_i32 s51, 4096
    v_xad_u32 v55, v55, v3, s51
    v_mad_u32_u24 v254, v54, s50, v55
    v_add_u32 v54, 2280, v52
    v_lshrrev_b32 v55, 5, v54
    v_and_b32 v55, 0x60, v55
    v_lshrrev_b32 v54, 11, v54
    s_movk_i32 s51, 4096
    v_xad_u32 v55, v55, v3, s51
    v_mad_u32_u24 v255, v54, s50, v55
    v_add_u32 v54, 2736, v52
    v_lshrrev_b32 v55, 5, v54
    v_and_b32 v55, 0x60, v55
    v_lshrrev_b32 v54, 11, v54
    s_movk_i32 s51, 4096
    v_xad_u32 v55, v55, v3, s51
    v_mad_u32_u24 v224, v54, s50, v55
    v_add_u32 v54, 3192, v52
    v_lshrrev_b32 v55, 5, v54
    v_and_b32 v55, 0x60, v55
    v_lshrrev_b32 v54, 11, v54
    s_movk_i32 s51, 4096
    v_xad_u32 v55, v55, v3, s51
    v_mad_u32_u24 v225, v54, s50, v55
    v_add_u32 v54, 3648, v52
    v_lshrrev_b32 v55, 5, v54
    v_and_b32 v55, 0x60, v55
    v_lshrrev_b32 v54, 11, v54
    s_movk_i32 s51, 8192
    v_xad_u32 v55, v55, v3, s51
    v_mad_u32_u24 v226, v54, s50, v55
    s_mul_i32 s51, s34, 456
    v_add_u32 v54, s51, v52
    v_lshrrev_b32 v55, 5, v54
    v_and_b32 v55, 0x60, v55
    v_lshrrev_b32 v54, 11, v54
    s_lshl_b32 s51, s34, 10
    v_xad_u32 v55, v55, v3, s51
    v_mad_u32_u24 v7, v54, s50, v55
    buffer_load_dword v5, v4, s[12:15], s53 offen
    s_mov_b32 m0, s46
    s_nop 0
    buffer_load_dwordx4 v8, s[8:11], s47 offen  lds
    buffer_load_dwordx4 v9, s[8:11], s47 offen offset:1024  lds
    buffer_load_dwordx4 v10, s[8:11], s47 offen offset:2048  lds
    buffer_load_dwordx4 v11, s[8:11], s47 offen offset:3072  lds
    s_load_dwordx2 s[12:13], s[0:1], 32
    v_add_u32 v252, s53, v4
    s_load_dwordx2 s[20:21], s[0:1], 80
    s_movk_i32 s22, 1152
    s_waitcnt lgkmcnt(0)
    s_mul_i32 s36, s35, 0x41c64e6d
    s_add_u32 s36, s36, 0x3c6ef35f
    s_mul_i32 s37, s36, 0x2c9277b5
    s_add_u32 s37, s37, 0xac564b05
    s_mov_b32 s60, 0x00010001
    s_bfe_i32 s50, s36, 0x10000
    v_mov_b32 v63, s50
    buffer_load_dword v5, v49, s[4:7], 0 offen sc1
    s_add_u32 m0, m0, 4096
    s_nop 0
    buffer_load_dwordx4 v12, s[8:11], s47 offen  lds
    buffer_load_dwordx4 v13, s[8:11], s47 offen offset:1024  lds
    buffer_load_dwordx4 v14, s[8:11], s47 offen offset:2048  lds
    buffer_load_dwordx4 v15, s[8:11], s47 offen offset:3072  lds
    s_add_u32 m0, m0, 4096
    s_nop 0
    buffer_load_dwordx4 v16, s[8:11], s47 offen  lds
    buffer_load_dwordx4 v17, s[8:11], s47 offen offset:1024  lds
    buffer_load_dwordx4 v18, s[8:11], s47 offen offset:2048  lds
    buffer_load_dwordx4 v19, s[8:11], s47 offen offset:3072  lds
    s_add_u32 m0, m0, 4096
    s_nop 0
    buffer_load_dwordx4 v20, s[8:11], s47 offen  lds
    buffer_load_dwordx4 v21, s[8:11], s47 offen offset:1024  lds
    buffer_load_dwordx4 v22, s[8:11], s47 offen offset:2048  lds
    buffer_load_dwordx4 v23, s[8:11], s47 offen offset:3072  lds
    s_xor_b32 s47, s47, 65536
    s_add_u32 m0, s46, 0x4000
    s_nop 0
    buffer_load_dwordx4 v8, s[8:11], s47 offen  lds
    buffer_load_dwordx4 v9, s[8:11], s47 offen offset:1024  lds
    buffer_load_dwordx4 v10, s[8:11], s47 offen offset:2048  lds
    buffer_load_dwordx4 v11, s[8:11], s47 offen offset:3072  lds
    s_add_u32 m0, m0, 4096
    s_nop 0
    buffer_load_dwordx4 v12, s[8:11], s47 offen  lds
    buffer_load_dwordx4 v13, s[8:11], s47 offen offset:1024  lds
    buffer_load_dwordx4 v14, s[8:11], s47 offen offset:2048  lds
    buffer_load_dwordx4 v15, s[8:11], s47 offen offset:3072  lds
    s_add_u32 m0, m0, 4096
    s_nop 0
    buffer_load_dwordx4 v16, s[8:11], s47 offen  lds
    buffer_load_dwordx4 v17, s[8:11], s47 offen offset:1024  lds
    buffer_load_dwordx4 v18, s[8:11], s47 offen offset:2048  lds
    buffer_load_dwordx4 v19, s[8:11], s47 offen offset:3072  lds
    s_add_u32 m0, m0, 4096
    s_nop 0
    buffer_load_dwordx4 v20, s[8:11], s47 offen  lds
    buffer_load_dwordx4 v21, s[8:11], s47 offen offset:1024  lds
    buffer_load_dwordx4 v22, s[8:11], s47 offen offset:2048  lds
    buffer_load_dwordx4 v23, s[8:11], s47 offen offset:3072  lds
    s_movk_i32 s55, 4096
    s_mov_b32 s54, 0
    s_branch L_q_skip
L_q_retry:
    s_mov_b32 s61, m0
    s_mov_b32 m0, s48
    s_nop 0
    buffer_load_dwordx4 v44, s[4:7], 0 offen offset:0 sc1 lds
    buffer_load_dwordx4 v245, s[4:7], 0 offen offset:1024 sc1 lds
    buffer_load_dwordx4 v44, s[4:7], 0 offen offset:2048 sc1 lds
    buffer_load_dwordx4 v245, s[4:7], 0 offen offset:3072 sc1 lds
    s_add_u32 m0, m0, 4096
    s_nop 0
    buffer_load_dwordx4 v44, s[4:7], s55 offen offset:0 sc1 lds
    buffer_load_dwordx4 v245, s[4:7], s55 offen offset:1024 sc1 lds
    buffer_load_dwordx4 v44, s[4:7], s55 offen offset:2048 sc1 lds
    buffer_load_dwordx4 v245, s[4:7], s55 offen offset:3072 sc1 lds
    s_mov_b32 m0, s61
    s_add_u32 s54, s54, 1
    s_cmp_gt_u32 s54, 131072
    s_waitcnt vmcnt(0)
    s_cbranch_scc1 L_q_ok
    s_branch L_q_chk
L_q_skip:
L_pg5:
    s_waitcnt vmcnt(16)
    s_barrier
    ds_read_b128 a[0:3], v24 offset:0
    ds_read_b128 a[4:7], v25 offset:0
    ds_read_b128 a[8:11], v26 offset:0
    ds_read_b128 a[12:15], v27 offset:0
    ds_read_b128 a[16:19], v24 offset:256
    ds_read_b128 a[20:23], v25 offset:256
    ds_read_b128 a[24:27], v26 offset:256
    ds_read_b128 a[28:31], v27 offset:256
    ds_read_b128 a[32:35], v24 offset:512
    ds_read_b128 a[36:39], v25 offset:512
    ds_read_b128 a[40:43], v26 offset:512
    ds_read_b128 a[44:47], v27 offset:512
    ds_read_b128 a[48:51], v24 offset:768
    ds_read_b128 a[52:55], v25 offset:768
    ds_read_b128 a[56:59], v26 offset:768
    ds_read_b128 a[60:63], v27 offset:768
    ds_read_b64_tr_b16 a[128:129], v28 offset:0
    ds_read_b64_tr_b16 a[132:133], v29 offset:0
    ds_read_b64_tr_b16 a[136:137], v30 offset:0
    ds_read_b64_tr_b16 a[140:141], v31 offset:0
    ds_read_b64_tr_b16 a[144:145], v32 offset:0
    ds_read_b64_tr_b16 a[148:149], v33 offset:0
    ds_read_b64_tr_b16 a[152:153], v34 offset:0
    ds_read_b64_tr_b16 a[156:157], v35 offset:0
    ds_read_b64_tr_b16 a[160:161], v28 offset:32768
    ds_read_b64_tr_b16 a[164:165], v29 offset:32768
    ds_read_b64_tr_b16 a[168:169], v30 offset:32768
    ds_read_b64_tr_b16 a[172:173], v31 offset:32768
    ds_read_b64_tr_b16 a[176:177], v32 offset:32768
    ds_read_b64_tr_b16 a[180:181], v33 offset:32768
    ds_read_b64_tr_b16 a[184:185], v34 offset:32768
    ds_read_b64_tr_b16 a[188:189], v35 offset:32768
    ds_read_b64_tr_b16 a[192:193], v36 offset:0
    ds_read_b64_tr_b16 a[196:197], v37 offset:0
    ds_read_b64_tr_b16 a[200:201], v38 offset:0
    ds_read_b64_tr_b16 a[204:205], v39 offset:0
    ds_read_b64_tr_b16 a[208:209], v40 offset:0
    ds_read_b64_tr_b16 a[212:213], v41 offset:0
    ds_read_b64_tr_b16 a[216:217], v42 offset:0
    ds_read_b64_tr_b16 a[220:221], v43 offset:0
    ds_read_b64_tr_b16 a[224:225], v36 offset:32768
    ds_read_b64_tr_b16 a[228:229], v37 offset:32768
    ds_read_b64_tr_b16 a[232:233], v38 offset:32768
    ds_read_b64_tr_b16 a[236:237], v39 offset:32768
    ds_read_b64_tr_b16 a[240:241], v40 offset:32768
    ds_read_b64_tr_b16 a[244:245], v41 offset:32768
    ds_read_b64_tr_b16 a[248:249], v42 offset:32768
    ds_read_b64_tr_b16 a[252:253], v43 offset:32768
    s_xor_b32 s44, s45, 65536
    s_waitcnt lgkmcnt(0)
    s_barrier
    s_mov_b32 m0, s46
    s_nop 0
    buffer_load_dwordx4 v8, s[8:11], s45 offen nt lds
    buffer_load_dwordx4 v9, s[8:11], s45 offen offset:1024 nt lds
    buffer_load_dwordx4 v10, s[8:11], s45 offen offset:2048 nt lds
    buffer_load_dwordx4 v11, s[8:11], s45 offen offset:3072 nt lds
    s_add_u32 m0, m0, 4096
    s_nop 0
    buffer_load_dwordx4 v12, s[8:11], s45 offen nt lds
    buffer_load_dwordx4 v13, s[8:11], s45 offen offset:1024 nt lds
    buffer_load_dwordx4 v14, s[8:11], s45 offen offset:2048 nt lds
    buffer_load_dwordx4 v15, s[8:11], s45 offen offset:3072 nt lds
    s_mov_b32 s61, m0
    s_mov_b32 m0, s48
    s_nop 0
    buffer_load_dwordx4 v44, s[4:7], 0 offen offset:0 sc1 lds
    buffer_load_dwordx4 v245, s[4:7], 0 offen offset:1024 sc1 lds
    buffer_load_dwordx4 v44, s[4:7], 0 offen offset:2048 sc1 lds
    buffer_load_dwordx4 v245, s[4:7], 0 offen offset:3072 sc1 lds
    s_add_u32 m0, m0, 4096
    s_nop 0
    buffer_load_dwordx4 v44, s[4:7], s55 offen offset:0 sc1 lds
    buffer_load_dwordx4 v245, s[4:7], s55 offen offset:1024 sc1 lds
    buffer_load_dwordx4 v44, s[4:7], s55 offen offset:2048 sc1 lds
    buffer_load_dwordx4 v245, s[4:7], s55 offen offset:3072 sc1 lds
    s_mov_b32 m0, s61
    s_branch L_pg6
.p2align 12
L_pg6:
    s_waitcnt vmcnt(16)
    s_barrier
    ds_read_b128 a[64:67], v24 offset:16384
    s_add_u32 m0, m0, 4096
    s_nop 0
    buffer_load_dwordx4 v16, s[8:11], s45 offen nt lds
    ds_read_b128 a[68:71], v25 offset:16384
    ds_read_b128 a[72:75], v26 offset:16384
    buffer_load_dwordx4 v17, s[8:11], s45 offen offset:1024 nt lds
    ds_read_b128 a[76:79], v27 offset:16384
    ds_read_b128 a[80:83], v24 offset:16640
    buffer_load_dwordx4 v18, s[8:11], s45 offen offset:2048 nt lds
    ds_read_b128 a[84:87], v25 offset:16640
    ds_read_b128 a[88:91], v26 offset:16640
    buffer_load_dwordx4 v19, s[8:11], s45 offen offset:3072 nt lds
    ds_read_b128 a[92:95], v27 offset:16640
    ds_read_b128 a[96:99], v24 offset:16896
    s_add_u32 m0, m0, 4096
    s_nop 0
    buffer_load_dwordx4 v20, s[8:11], s45 offen nt lds
    ds_read_b128 a[100:103], v25 offset:16896
    ds_read_b128 a[104:107], v26 offset:16896
    buffer_load_dwordx4 v21, s[8:11], s45 offen offset:1024 nt lds
    ds_read_b128 a[108:111], v27 offset:16896
    ds_read_b128 a[112:115], v24 offset:17152
    buffer_load_dwordx4 v22, s[8:11], s45 offen offset:2048 nt lds
    ds_read_b128 a[116:119], v25 offset:17152
    ds_read_b128 a[120:123], v26 offset:17152
    buffer_load_dwordx4 v23, s[8:11], s45 offen offset:3072 nt lds
    ds_read_b128 a[124:127], v27 offset:17152
    ds_read_b64_tr_b16 a[130:131], v28 offset:16384
    ds_read_b64_tr_b16 a[134:135], v29 offset:16384
    ds_read_b64_tr_b16 a[138:139], v30 offset:16384
    ds_read_b64_tr_b16 a[142:143], v31 offset:16384
    ds_read_b64_tr_b16 a[146:147], v32 offset:16384
    ds_read_b64_tr_b16 a[150:151], v33 offset:16384
    ds_read_b64_tr_b16 a[154:155], v34 offset:16384
    ds_read_b64_tr_b16 a[158:159], v35 offset:16384
    ds_read_b64_tr_b16 a[162:163], v28 offset:49152
    ds_read_b64_tr_b16 a[166:167], v29 offset:49152
    ds_read_b64_tr_b16 a[170:171], v30 offset:49152
    ds_read_b64_tr_b16 a[174:175], v31 offset:49152
    ds_read_b64_tr_b16 a[178:179], v32 offset:49152
    ds_read_b64_tr_b16 a[182:183], v33 offset:49152
    ds_read_b64_tr_b16 a[186:187], v34 offset:49152
    ds_read_b64_tr_b16 a[190:191], v35 offset:49152
    ds_read_b64_tr_b16 a[194:195], v36 offset:16384
    ds_read_b64_tr_b16 a[198:199], v37 offset:16384
    ds_read_b64_tr_b16 a[202:203], v38 offset:16384
    ds_read_b64_tr_b16 a[206:207], v39 offset:16384
    ds_read_b64_tr_b16 a[210:211], v40 offset:16384
    ds_read_b64_tr_b16 a[214:215], v41 offset:16384
    ds_read_b64_tr_b16 a[218:219], v42 offset:16384
    ds_read_b64_tr_b16 a[222:223], v43 offset:16384
    ds_read_b64_tr_b16 a[226:227], v36 offset:49152
    ds_read_b64_tr_b16 a[230:231], v37 offset:49152
    ds_read_b64_tr_b16 a[234:235], v38 offset:49152
    ds_read_b64_tr_b16 a[238:239], v39 offset:49152
    ds_read_b64_tr_b16 a[242:243], v40 offset:49152
    ds_read_b64_tr_b16 a[246:247], v41 offset:49152
    ds_read_b64_tr_b16 a[250:251], v42 offset:49152
    ds_read_b64_tr_b16 a[254:255], v43 offset:49152
    s_waitcnt vmcnt(8)
L_q_chk:
    ds_read_b64 v[52:53], v244 offset:0
    ds_read_b64 v[54:55], v244 offset:2048
    ds_read_b64 v[56:57], v244 offset:4096
    ds_read_b64 v[58:59], v244 offset:6144
    s_waitcnt lgkmcnt(0)
    v_bitop3_b32 v52, v52, v54, s36 bitop3:0x7e
    v_bitop3_b32 v56, v56, v58, s36 bitop3:0x7e
    v_bitop3_b32 v53, v53, v55, s37 bitop3:0x7e
    v_bitop3_b32 v57, v57, v59, s37 bitop3:0x7e
    v_or3_b32 v52, v52, v56, v53
    v_or_b32 v52, v52, v57
    v_cmp_ne_u32 vcc, 0, v52
    s_cbranch_vccnz L_q_retry
L_q_ok:
    s_barrier
    ds_read_b128 v[64:67], v51 offset:0
    ds_read_b128 v[68:71], v51 offset:2048
    ds_read_b128 v[72:75], v51 offset:4096
    ds_read_b128 v[76:79], v51 offset:6144
    ds_read_b128 v[80:83], v51 offset:8192
    ds_read_b128 v[84:87], v51 offset:10240
    s_add_u32 m0, s46, 0x4000
    s_nop 0
    buffer_load_dwordx4 v8, s[8:11], s44 offen nt lds
    buffer_load_dwordx4 v9, s[8:11], s44 offen offset:1024 nt lds
    buffer_load_dwordx4 v10, s[8:11], s44 offen offset:2048 nt lds
    buffer_load_dwordx4 v11, s[8:11], s44 offen offset:3072 nt lds
    s_waitcnt lgkmcnt(5)
    v_mfma_f32_16x16x32_bf16 v[228:231], a[0:3], v[64:67], 0
    ds_read_b128 v[88:91], v51 offset:12288
    v_mfma_f32_16x16x32_bf16 v[232:235], a[64:67], v[64:67], 0
    s_waitcnt lgkmcnt(5)
    v_mfma_f32_16x16x32_bf16 v[228:231], a[4:7], v[68:71], v[228:231]
    ds_read_b128 v[92:95], v51 offset:14336
    v_mfma_f32_16x16x32_bf16 v[232:235], a[68:71], v[68:71], v[232:235]
    s_add_u32 m0, m0, 4096
    s_nop 0
    buffer_load_dwordx4 v12, s[8:11], s44 offen nt lds
    s_waitcnt lgkmcnt(5)
    v_mfma_f32_16x16x32_bf16 v[228:231], a[8:11], v[72:75], v[228:231]
    ds_read_b128 v[96:99], v51 offset:16384
    v_mfma_f32_16x16x32_bf16 v[232:235], a[72:75], v[72:75], v[232:235]
    s_waitcnt lgkmcnt(5)
    v_mfma_f32_16x16x32_bf16 v[228:231], a[12:15], v[76:79], v[228:231]
    ds_read_b128 v[100:103], v51 offset:18432
    v_mfma_f32_16x16x32_bf16 v[232:235], a[76:79], v[76:79], v[232:235]
    buffer_load_dwordx4 v13, s[8:11], s44 offen offset:1024 nt lds
    s_waitcnt lgkmcnt(5)
    v_mfma_f32_16x16x32_bf16 v[228:231], a[16:19], v[80:83], v[228:231]
    ds_read_b128 v[104:107], v51 offset:20480
    v_mfma_f32_16x16x32_bf16 v[232:235], a[80:83], v[80:83], v[232:235]
    s_waitcnt lgkmcnt(5)
    v_mfma_f32_16x16x32_bf16 v[228:231], a[20:23], v[84:87], v[228:231]
    ds_read_b128 v[108:111], v51 offset:22528
    v_mfma_f32_16x16x32_bf16 v[232:235], a[84:87], v[84:87], v[232:235]
    buffer_load_dwordx4 v14, s[8:11], s44 offen offset:2048 nt lds
    s_waitcnt lgkmcnt(5)
    v_mfma_f32_16x16x32_bf16 v[228:231], a[24:27], v[88:91], v[228:231]
    ds_read_b128 v[112:115], v51 offset:24576
    v_mfma_f32_16x16x32_bf16 v[232:235], a[88:91], v[88:91], v[232:235]
    s_waitcnt lgkmcnt(5)
    v_mfma_f32_16x16x32_bf16 v[228:231], a[28:31], v[92:95], v[228:231]
    ds_read_b128 v[116:119], v51 offset:26624
    v_mfma_f32_16x16x32_bf16 v[232:235], a[92:95], v[92:95], v[232:235]
    buffer_load_dwordx4 v15, s[8:11], s44 offen offset:3072 nt lds
    s_waitcnt lgkmcnt(5)
    v_mfma_f32_16x16x32_bf16 v[228:231], a[32:35], v[96:99], v[228:231]
    ds_read_b128 v[120:123], v51 offset:28672
    v_mfma_f32_16x16x32_bf16 v[232:235], a[96:99], v[96:99], v[232:235]
    s_waitcnt lgkmcnt(5)
    v_mfma_f32_16x16x32_bf16 v[228:231], a[36:39], v[100:103], v[228:231]
    ds_read_b128 v[124:127], v51 offset:30720
    v_mfma_f32_16x16x32_bf16 v[232:235], a[100:103], v[100:103], v[232:235]
    s_add_u32 m0, m0, 4096
    s_nop 0
    buffer_load_dwordx4 v16, s[8:11], s44 offen nt lds
    s_waitcnt vmcnt(9)
    s_waitcnt lgkmcnt(5)
    v_mfma_f32_16x16x32_bf16 v[228:231], a[40:43], v[104:107], v[228:231]
    ds_read_b128 a[0:3], v24 offset:0
    v_mfma_f32_16x16x32_bf16 v[232:235], a[104:107], v[104:107], v[232:235]
    ds_read_b128 a[4:7], v25 offset:0
    s_waitcnt lgkmcnt(6)
    v_mfma_f32_16x16x32_bf16 v[228:231], a[44:47], v[108:111], v[228:231]
    ds_read_b128 a[8:11], v26 offset:0
    v_mfma_f32_16x16x32_bf16 v[232:235], a[108:111], v[108:111], v[232:235]
    buffer_load_dwordx4 v17, s[8:11], s44 offen offset:1024 nt lds
    ds_read_b128 a[12:15], v27 offset:0
    s_waitcnt lgkmcnt(7)
    v_mfma_f32_16x16x32_bf16 v[228:231], a[48:51], v[112:115], v[228:231]
    ds_read_b128 a[16:19], v24 offset:256
    v_mfma_f32_16x16x32_bf16 v[232:235], a[112:115], v[112:115], v[232:235]
    ds_read_b128 a[20:23], v25 offset:256
    s_waitcnt lgkmcnt(8)
    v_mfma_f32_16x16x32_bf16 v[228:231], a[52:55], v[116:119], v[228:231]
    ds_read_b128 a[24:27], v26 offset:256
    v_mfma_f32_16x16x32_bf16 v[232:235], a[116:119], v[116:119], v[232:235]
    buffer_load_dwordx4 v18, s[8:11], s44 offen offset:2048 nt lds
    ds_read_b128 a[28:31], v27 offset:256
    s_waitcnt lgkmcnt(9)
    v_mfma_f32_16x16x32_bf16 v[228:231], a[56:59], v[120:123], v[228:231]
    ds_read_b128 a[32:35], v24 offset:512
    v_mfma_f32_16x16x32_bf16 v[232:235], a[120:123], v[120:123], v[232:235]
    ds_read_b128 a[36:39], v25 offset:512
    s_waitcnt lgkmcnt(10)
    v_mfma_f32_16x16x32_bf16 v[228:231], a[60:63], v[124:127], v[228:231]
    ds_read_b128 a[40:43], v26 offset:512
    v_mfma_f32_16x16x32_bf16 v[232:235], a[124:127], v[124:127], v[232:235]
    buffer_load_dwordx4 v19, s[8:11], s44 offen offset:3072 nt lds
    ds_read_b128 a[44:47], v27 offset:512
    s_waitcnt lgkmcnt(6)
    v_mfma_f32_16x16x32_bf16 v[236:239], a[0:3], v[64:67], 0
    ds_read_b128 a[48:51], v24 offset:768
    ds_read_b128 a[52:55], v25 offset:768
    v_mfma_f32_16x16x32_bf16 v[236:239], a[4:7], v[68:71], v[236:239]
    ds_read_b128 a[56:59], v26 offset:768
    ds_read_b128 a[60:63], v27 offset:768
    v_mfma_f32_16x16x32_bf16 v[236:239], a[8:11], v[72:75], v[236:239]
    s_add_u32 m0, m0, 4096
    s_nop 0
    buffer_load_dwordx4 v20, s[8:11], s44 offen nt lds
    s_barrier
    v_mfma_f32_16x16x32_bf16 v[236:239], a[12:15], v[76:79], v[236:239]
    v_max3_f32 v52, v228, v229, v230
    v_max3_f32 v53, v232, v233, v234
    v_mfma_f32_16x16x32_bf16 v[236:239], a[16:19], v[80:83], v[236:239]
    v_max3_f32 v52, v52, v231, v235
    v_max_f32 v52, v52, v53
    v_mfma_f32_16x16x32_bf16 v[236:239], a[20:23], v[84:87], v[236:239]
    v_mov_b32 v53, v52
    s_waitcnt lgkmcnt(4)
    v_mfma_f32_16x16x32_bf16 v[236:239], a[24:27], v[88:91], v[236:239]
    v_permlane32_swap_b32 v52, v53
    v_max_f32 v52, v52, v53
    v_mfma_f32_16x16x32_bf16 v[236:239], a[28:31], v[92:95], v[236:239]
    v_mov_b32 v53, v52
    buffer_load_dwordx4 v21, s[8:11], s44 offen offset:1024 nt lds
    v_mfma_f32_16x16x32_bf16 v[236:239], a[32:35], v[96:99], v[236:239]
    v_permlane16_swap_b32 v52, v53
    v_max_f32 v52, v52, v53
    v_mfma_f32_16x16x32_bf16 v[236:239], a[36:39], v[100:103], v[236:239]
    buffer_load_dwordx4 v22, s[8:11], s44 offen offset:2048 nt lds
    v_mfma_f32_16x16x32_bf16 v[236:239], a[40:43], v[104:107], v[236:239]
    buffer_load_dwordx4 v23, s[8:11], s44 offen offset:3072 nt lds
    v_mfma_f32_16x16x32_bf16 v[236:239], a[44:47], v[108:111], v[236:239]
    s_waitcnt lgkmcnt(0)
    v_mfma_f32_16x16x32_bf16 v[236:239], a[48:51], v[112:115], v[236:239]
    ds_read_b64_tr_b16 a[96:97], v36 offset:32768
    ds_read_b64_tr_b16 a[100:101], v37 offset:32768
    v_mfma_f32_16x16x32_bf16 v[236:239], a[52:55], v[116:119], v[236:239]
    ds_read_b64_tr_b16 a[104:105], v38 offset:32768
    ds_read_b64_tr_b16 a[108:109], v39 offset:32768
    v_mfma_f32_16x16x32_bf16 v[236:239], a[56:59], v[120:123], v[236:239]
    ds_read_b64_tr_b16 a[112:113], v40 offset:32768
    ds_read_b64_tr_b16 a[116:117], v41 offset:32768
    v_mfma_f32_16x16x32_bf16 v[236:239], a[60:63], v[124:127], v[236:239]
    ds_read_b64_tr_b16 a[120:121], v42 offset:32768
    ds_read_b64_tr_b16 a[124:125], v43 offset:32768
    ds_read_b64_tr_b16 a[0:1], v28 offset:0
    ds_read_b64_tr_b16 a[4:5], v29 offset:0
    ds_read_b64_tr_b16 a[8:9], v30 offset:0
    ds_read_b64_tr_b16 a[12:13], v31 offset:0
    ds_read_b64_tr_b16 a[16:17], v32 offset:0
    ds_read_b64_tr_b16 a[20:21], v33 offset:0
    ds_read_b64_tr_b16 a[24:25], v34 offset:0
    ds_read_b64_tr_b16 a[28:29], v35 offset:0
    ds_read_b64_tr_b16 a[32:33], v28 offset:32768
    ds_read_b64_tr_b16 a[36:37], v29 offset:32768
    ds_read_b64_tr_b16 a[40:41], v30 offset:32768
    ds_read_b64_tr_b16 a[44:45], v31 offset:32768
    ds_read_b64_tr_b16 a[48:49], v32 offset:32768
    ds_read_b64_tr_b16 a[52:53], v33 offset:32768
    ds_read_b64_tr_b16 a[56:57], v34 offset:32768
    ds_read_b64_tr_b16 a[60:61], v35 offset:32768
    ds_write_b32 v46, v52 offset:0
L_pg7:
    s_waitcnt vmcnt(0)
    ds_read_b128 v[128:131], v24 offset:16384
    ds_read_b128 v[132:135], v25 offset:16384
    ds_read_b128 v[136:139], v26 offset:16384
    ds_read_b128 v[140:143], v27 offset:16384
    ds_read_b128 v[144:147], v24 offset:16640
    ds_read_b128 v[148:151], v25 offset:16640
    s_waitcnt lgkmcnt(6)
    s_barrier
    ds_read_b128 v[56:59], v47
    ds_read_b128 v[152:155], v26 offset:16640
    ds_read_b128 v[156:159], v27 offset:16640
    ds_read_b128 a[64:67], v24 offset:16896
    ds_read_b128 a[68:71], v25 offset:16896
    buffer_load_dword v253, v252, s[12:15], 0 offen
    s_waitcnt lgkmcnt(5)
    v_mfma_f32_16x16x32_bf16 v[240:243], v[128:131], v[64:67], 0
    ds_read_b128 a[72:75], v26 offset:16896
    ds_read_b128 a[76:79], v27 offset:16896
    v_mfma_f32_16x16x32_bf16 v[240:243], v[132:135], v[68:71], v[240:243]
    ds_read_b128 a[80:83], v24 offset:17152
    ds_read_b128 a[84:87], v25 offset:17152
    v_mfma_f32_16x16x32_bf16 v[240:243], v[136:139], v[72:75], v[240:243]
    ds_read_b128 a[88:91], v26 offset:17152
    ds_read_b128 a[92:95], v27 offset:17152
    v_mfma_f32_16x16x32_bf16 v[240:243], v[140:143], v[76:79], v[240:243]
    s_waitcnt lgkmcnt(10)
    v_max3_f32 v60, v56, v57, v58
    v_max_f32 v60, v60, v59
    v_sub_f32 v228, v228, v60
    v_sub_f32 v229, v229, v60
    v_mfma_f32_16x16x32_bf16 v[240:243], v[144:147], v[80:83], v[240:243]
    v_exp_f32 v228, v228
    v_sub_f32 v230, v230, v60
    v_exp_f32 v229, v229
    v_sub_f32 v231, v231, v60
    v_mfma_f32_16x16x32_bf16 v[240:243], v[148:151], v[84:87], v[240:243]
    s_waitcnt lgkmcnt(6)
    v_exp_f32 v230, v230
    v_sub_f32 v232, v232, v60
    v_exp_f32 v231, v231
    v_sub_f32 v233, v233, v60
    v_mfma_f32_16x16x32_bf16 v[240:243], v[152:155], v[88:91], v[240:243]
    v_exp_f32 v232, v232
    v_sub_f32 v234, v234, v60
    v_exp_f32 v233, v233
    v_sub_f32 v235, v235, v60
    v_mfma_f32_16x16x32_bf16 v[240:243], v[156:159], v[92:95], v[240:243]
    v_exp_f32 v234, v234
    v_exp_f32 v235, v235
    v_mfma_f32_16x16x32_bf16 v[240:243], a[64:67], v[96:99], v[240:243]
    v_cvt_pk_bf16_f32 v244, v228, v229
    v_cvt_pk_bf16_f32 v245, v230, v231
    v_mfma_f32_16x16x32_bf16 v[240:243], a[68:71], v[100:103], v[240:243]
    s_waitcnt lgkmcnt(0)
    v_cvt_pk_bf16_f32 v246, v232, v233
    v_cvt_pk_bf16_f32 v247, v234, v235
    ds_write_b128 v50, v[244:247] offset:0
    v_mfma_f32_16x16x32_bf16 v[240:243], a[72:75], v[104:107], v[240:243]
    ds_read_b64_tr_b16 a[2:3], v28 offset:16384
    ds_read_b64_tr_b16 a[34:35], v28 offset:49152
    v_mfma_f32_16x16x32_bf16 v[240:243], a[76:79], v[108:111], v[240:243]
    ds_read_b64_tr_b16 a[98:99], v36 offset:49152
    ds_read_b64_tr_b16 a[6:7], v29 offset:16384
    v_mfma_f32_16x16x32_bf16 v[240:243], a[80:83], v[112:115], v[240:243]
    s_waitcnt lgkmcnt(4)
    s_barrier
    ds_read_b128 v[192:195], v45 offset:0
    ds_read_b128 v[196:199], v45 offset:1024
    ds_read_b128 v[200:203], v45 offset:2048
    ds_read_b128 v[204:207], v45 offset:3072
    v_mfma_f32_16x16x32_bf16 v[240:243], a[84:87], v[116:119], v[240:243]
    ds_read_b64_tr_b16 a[38:39], v29 offset:49152
    ds_read_b64_tr_b16 a[102:103], v37 offset:49152
    v_mfma_f32_16x16x32_bf16 v[240:243], a[88:91], v[120:123], v[240:243]
    ds_read_b64_tr_b16 a[10:11], v30 offset:16384
    ds_read_b64_tr_b16 a[42:43], v30 offset:49152
    v_mfma_f32_16x16x32_bf16 v[240:243], a[92:95], v[124:127], v[240:243]
    ds_read_b64_tr_b16 a[106:107], v38 offset:49152
    ds_read_b64_tr_b16 a[14:15], v31 offset:16384
    s_waitcnt lgkmcnt(6)
    v_mfma_f32_16x16x32_bf16 v[160:163], v[192:195], a[128:131], 0
    ds_read_b64_tr_b16 a[64:65], v36 offset:0
    ds_read_b64_tr_b16 a[66:67], v36 offset:16384
    v_mfma_f32_16x16x32_bf16 v[160:163], v[196:199], a[160:163], v[160:163]
    ds_read_b64_tr_b16 a[68:69], v37 offset:0
    ds_read_b64_tr_b16 a[70:71], v37 offset:16384
    v_mfma_f32_16x16x32_bf16 v[160:163], v[200:203], a[192:195], v[160:163]
    ds_read_b64_tr_b16 a[72:73], v38 offset:0
    ds_read_b64_tr_b16 a[74:75], v38 offset:16384
    v_mfma_f32_16x16x32_bf16 v[160:163], v[204:207], a[224:227], v[160:163]
    v_max3_f32 v52, v236, v237, v238
    v_max3_f32 v53, v240, v241, v242
    v_mfma_f32_16x16x32_bf16 v[164:167], v[192:195], a[132:135], 0
    v_max3_f32 v52, v52, v239, v243
    v_max_f32 v52, v52, v53
    v_mfma_f32_16x16x32_bf16 v[164:167], v[196:199], a[164:167], v[164:167]
    v_mov_b32 v53, v52
    ds_read_b64_tr_b16 a[46:47], v31 offset:49152
    v_mfma_f32_16x16x32_bf16 v[164:167], v[200:203], a[196:199], v[164:167]
    v_permlane32_swap_b32 v52, v53
    v_max_f32 v52, v52, v53
    v_mfma_f32_16x16x32_bf16 v[164:167], v[204:207], a[228:231], v[164:167]
    v_mov_b32 v53, v52
    ds_read_b64_tr_b16 a[76:77], v39 offset:0
    v_mfma_f32_16x16x32_bf16 v[168:171], v[192:195], a[136:139], 0
    v_permlane16_swap_b32 v52, v53
    v_max_f32 v52, v52, v53
    ds_write_b32 v46, v52 offset:2048
    v_mfma_f32_16x16x32_bf16 v[168:171], v[196:199], a[168:171], v[168:171]
    ds_read_b64_tr_b16 a[78:79], v39 offset:16384
    ds_read_b64_tr_b16 a[110:111], v39 offset:49152
    v_mfma_f32_16x16x32_bf16 v[168:171], v[200:203], a[200:203], v[168:171]
    ds_read_b64_tr_b16 a[18:19], v32 offset:16384
    ds_read_b64_tr_b16 a[50:51], v32 offset:49152
    v_mfma_f32_16x16x32_bf16 v[168:171], v[204:207], a[232:235], v[168:171]
    s_waitcnt lgkmcnt(4)
    s_barrier
    ds_read_b128 v[56:59], v47 offset:2048
    v_mfma_f32_16x16x32_bf16 v[172:175], v[192:195], a[140:143], 0
    ds_read_b64_tr_b16 a[80:81], v40 offset:0
    ds_read_b64_tr_b16 a[82:83], v40 offset:16384
    v_mfma_f32_16x16x32_bf16 v[172:175], v[196:199], a[172:175], v[172:175]
    ds_read_b64_tr_b16 a[114:115], v40 offset:49152
    ds_read_b64_tr_b16 a[22:23], v33 offset:16384
    v_mfma_f32_16x16x32_bf16 v[172:175], v[200:203], a[204:207], v[172:175]
    ds_read_b64_tr_b16 a[54:55], v33 offset:49152
    ds_read_b64_tr_b16 a[84:85], v41 offset:0
    v_mfma_f32_16x16x32_bf16 v[172:175], v[204:207], a[236:239], v[172:175]
    s_waitcnt lgkmcnt(6)
    v_max3_f32 v62, v56, v57, v58
    v_max3_f32 v62, v62, v59, v60
    v_mfma_f32_16x16x32_bf16 v[176:179], v[192:195], a[144:147], 0
    v_sub_f32 v236, v236, v62
    v_sub_f32 v237, v237, v62
    v_mfma_f32_16x16x32_bf16 v[176:179], v[196:199], a[176:179], v[176:179]
    v_exp_f32 v236, v236
    v_sub_f32 v238, v238, v62
    v_mfma_f32_16x16x32_bf16 v[176:179], v[200:203], a[208:211], v[176:179]
    v_exp_f32 v237, v237
    v_sub_f32 v239, v239, v62
    v_mfma_f32_16x16x32_bf16 v[176:179], v[204:207], a[240:243], v[176:179]
    v_exp_f32 v238, v238
    v_sub_f32 v240, v240, v62
    v_mfma_f32_16x16x32_bf16 v[180:183], v[192:195], a[148:151], 0
    v_exp_f32 v239, v239
    v_sub_f32 v241, v241, v62
    v_mfma_f32_16x16x32_bf16 v[180:183], v[196:199], a[180:183], v[180:183]
    v_exp_f32 v240, v240
    v_sub_f32 v242, v242, v62
    v_mfma_f32_16x16x32_bf16 v[180:183], v[200:203], a[212:215], v[180:183]
    v_exp_f32 v241, v241
    v_sub_f32 v243, v243, v62
    v_mfma_f32_16x16x32_bf16 v[180:183], v[204:207], a[244:247], v[180:183]
    v_exp_f32 v242, v242
    v_mov_b32 v68, 0x3f803f80
    v_mfma_f32_16x16x32_bf16 v[184:187], v[192:195], a[152:155], 0
    v_exp_f32 v243, v243
    v_mov_b32 v69, v68
    v_mfma_f32_16x16x32_bf16 v[184:187], v[196:199], a[184:187], v[184:187]
    v_cvt_pk_bf16_f32 v244, v236, v237
    v_cvt_pk_bf16_f32 v245, v238, v239
    v_mfma_f32_16x16x32_bf16 v[184:187], v[200:203], a[216:219], v[184:187]
    v_cvt_pk_bf16_f32 v246, v240, v241
    v_cvt_pk_bf16_f32 v247, v242, v243
    ds_write_b128 v50, v[244:247] offset:4096
    v_mfma_f32_16x16x32_bf16 v[184:187], v[204:207], a[248:251], v[184:187]
    v_sub_f32 v61, v60, v62
    v_exp_f32 v61, v61
    v_mfma_f32_16x16x32_bf16 v[188:191], v[192:195], a[156:159], 0
    ds_bpermute_b32 v64, v227, v61 offset:0
    ds_bpermute_b32 v65, v227, v61 offset:4
    ds_bpermute_b32 v66, v227, v61 offset:8
    ds_bpermute_b32 v67, v227, v61 offset:12
    v_mfma_f32_16x16x32_bf16 v[188:191], v[196:199], a[188:191], v[188:191]
    s_waitcnt lgkmcnt(4)
    s_barrier
    ds_read_b128 v[208:211], v45 offset:4096
    ds_read_b128 v[212:215], v45 offset:5120
    ds_read_b128 v[216:219], v45 offset:6144
    ds_read_b128 v[220:223], v45 offset:7168
    v_mfma_f32_16x16x32_bf16 v[188:191], v[200:203], a[220:223], v[188:191]
    ds_read_b64_tr_b16 a[86:87], v41 offset:16384
    ds_read_b64_tr_b16 a[118:119], v41 offset:49152
    v_mov_b32 v70, v68
    v_mov_b32 v71, v68
    v_mfma_f32_16x16x32_bf16 v[188:191], v[204:207], a[252:255], v[188:191]
    ds_read_b64_tr_b16 a[26:27], v34 offset:16384
    ds_read_b64_tr_b16 a[58:59], v34 offset:49152
    s_waitcnt lgkmcnt(8)
    v_mfma_f32_16x16x32_bf16 v[56:59], v[68:71], v[192:195], 0
    v_mul_f32 v160, v64, v160
    v_mul_f32 v161, v65, v161
    v_mul_f32 v162, v66, v162
    v_mfma_f32_16x16x32_bf16 v[56:59], v[68:71], v[196:199], v[56:59]
    v_mul_f32 v163, v67, v163
    v_mul_f32 v164, v64, v164
    v_mul_f32 v165, v65, v165
    v_mfma_f32_16x16x32_bf16 v[56:59], v[68:71], v[200:203], v[56:59]
    v_mul_f32 v166, v66, v166
    v_mul_f32 v167, v67, v167
    v_mul_f32 v168, v64, v168
    v_mfma_f32_16x16x32_bf16 v[56:59], v[68:71], v[204:207], v[56:59]
    v_mul_f32 v169, v65, v169
    v_mul_f32 v170, v66, v170
    v_mul_f32 v171, v67, v171
    s_waitcnt lgkmcnt(4)
    v_mfma_f32_16x16x32_bf16 v[160:163], v[208:211], a[0:3], v[160:163]
    ds_read_b64_tr_b16 a[88:89], v42 offset:0
    ds_read_b64_tr_b16 a[90:91], v42 offset:16384
    v_mfma_f32_16x16x32_bf16 v[160:163], v[212:215], a[32:35], v[160:163]
    ds_read_b64_tr_b16 a[122:123], v42 offset:49152
    ds_read_b64_tr_b16 a[30:31], v35 offset:16384
    v_mfma_f32_16x16x32_bf16 v[160:163], v[216:219], a[64:67], v[160:163]
    ds_read_b64_tr_b16 a[62:63], v35 offset:49152
    ds_read_b64_tr_b16 a[92:93], v43 offset:0
    v_mfma_f32_16x16x32_bf16 v[160:163], v[220:223], a[96:99], v[160:163]
    ds_read_b64_tr_b16 a[94:95], v43 offset:16384
    ds_read_b64_tr_b16 a[126:127], v43 offset:49152
    v_mfma_f32_16x16x32_bf16 v[164:167], v[208:211], a[4:7], v[164:167]
    v_mul_f32 v172, v64, v172
    v_mul_f32 v173, v65, v173
    v_mfma_f32_16x16x32_bf16 v[164:167], v[212:215], a[36:39], v[164:167]
    v_mul_f32 v174, v66, v174
    v_mul_f32 v175, v67, v175
    v_mfma_f32_16x16x32_bf16 v[164:167], v[216:219], a[68:71], v[164:167]
    v_mul_f32 v176, v64, v176
    v_mul_f32 v177, v65, v177
    v_mfma_f32_16x16x32_bf16 v[164:167], v[220:223], a[100:103], v[164:167]
    v_mul_f32 v178, v66, v178
    v_mul_f32 v179, v67, v179
    v_mfma_f32_16x16x32_bf16 v[168:171], v[208:211], a[8:11], v[168:171]
    v_mul_f32 v180, v64, v180
    v_mul_f32 v181, v65, v181
    v_mfma_f32_16x16x32_bf16 v[168:171], v[212:215], a[40:43], v[168:171]
    v_mul_f32 v182, v66, v182
    v_mul_f32 v183, v67, v183
    v_mfma_f32_16x16x32_bf16 v[168:171], v[216:219], a[72:75], v[168:171]
    v_mul_f32 v184, v64, v184
    v_mul_f32 v185, v65, v185
    v_mfma_f32_16x16x32_bf16 v[168:171], v[220:223], a[104:107], v[168:171]
    v_mul_f32 v186, v66, v186
    v_mul_f32 v187, v67, v187
    v_mfma_f32_16x16x32_bf16 v[172:175], v[208:211], a[12:15], v[172:175]
    v_mul_f32 v188, v64, v188
    v_mul_f32 v189, v65, v189
    v_mfma_f32_16x16x32_bf16 v[172:175], v[212:215], a[44:47], v[172:175]
    v_mul_f32 v190, v66, v190
    v_mul_f32 v191, v67, v191
    v_mfma_f32_16x16x32_bf16 v[172:175], v[216:219], a[76:79], v[172:175]
    s_waitcnt lgkmcnt(0)
    s_mov_b32 s52, 0x30000
    s_mov_b32 s56, 0x10000
    s_mov_b32 s57, 0x20000
    v_mfma_f32_16x16x32_bf16 v[172:175], v[220:223], a[108:111], v[172:175]
    v_cvt_pk_bf16_f32 v128, v160, v164
    v_bfi_b32 v128, s60, v63, v128
    v_mfma_f32_16x16x32_bf16 v[176:179], v[208:211], a[16:19], v[176:179]
    v_cvt_pk_bf16_f32 v132, v161, v165
    v_bfi_b32 v132, s60, v63, v132
    v_mfma_f32_16x16x32_bf16 v[176:179], v[212:215], a[48:51], v[176:179]
    v_cvt_pk_bf16_f32 v136, v162, v166
    v_bfi_b32 v136, s60, v63, v136
    v_mfma_f32_16x16x32_bf16 v[176:179], v[216:219], a[80:83], v[176:179]
    v_cvt_pk_bf16_f32 v140, v163, v167
    v_bfi_b32 v140, s60, v63, v140
    v_mfma_f32_16x16x32_bf16 v[176:179], v[220:223], a[112:115], v[176:179]
    v_cvt_pk_bf16_f32 v129, v168, v172
    v_bfi_b32 v129, s60, v63, v129
    buffer_store_dwordx2 v[128:129], v48, s[4:7], 0 offen offset:0 sc1
    v_mfma_f32_16x16x32_bf16 v[180:183], v[208:211], a[20:23], v[180:183]
    v_cvt_pk_bf16_f32 v133, v169, v173
    v_bfi_b32 v133, s60, v63, v133
    buffer_store_dwordx2 v[132:133], v48, s[4:7], s56 offen offset:0 sc1
    v_mfma_f32_16x16x32_bf16 v[180:183], v[212:215], a[52:55], v[180:183]
    v_cvt_pk_bf16_f32 v137, v170, v174
    v_bfi_b32 v137, s60, v63, v137
    buffer_store_dwordx2 v[136:137], v48, s[4:7], s57 offen offset:0 sc1
    v_mfma_f32_16x16x32_bf16 v[180:183], v[216:219], a[84:87], v[180:183]
    v_cvt_pk_bf16_f32 v141, v171, v175
    v_bfi_b32 v141, s60, v63, v141
    buffer_store_dwordx2 v[140:141], v48, s[4:7], s52 offen offset:0 sc1
    v_mfma_f32_16x16x32_bf16 v[180:183], v[220:223], a[116:119], v[180:183]
    s_barrier
    v_mfma_f32_16x16x32_bf16 v[184:187], v[208:211], a[24:27], v[184:187]
    v_mov_b32 v228, v62
    v_mov_b32 v230, s36
    v_mfma_f32_16x16x32_bf16 v[184:187], v[212:215], a[56:59], v[184:187]
    v_mov_b32 v231, s37
    v_mfma_f32_16x16x32_bf16 v[184:187], v[216:219], a[88:91], v[184:187]
    v_mfma_f32_16x16x32_bf16 v[184:187], v[220:223], a[120:123], v[184:187]
    v_cvt_pk_bf16_f32 v130, v176, v180
    v_bfi_b32 v130, s60, v63, v130
    v_mfma_f32_16x16x32_bf16 v[188:191], v[208:211], a[28:31], v[188:191]
    s_lshl2_add_u32 s53, s62, s59
    s_mov_b32 m0, s62
    v_mfma_f32_16x16x32_bf16 v[188:191], v[212:215], a[60:63], v[188:191]
    v_cvt_pk_bf16_f32 v134, v177, v181
    v_bfi_b32 v134, s60, v63, v134
    v_mfma_f32_16x16x32_bf16 v[188:191], v[216:219], a[92:95], v[188:191]
    v_cvt_pk_bf16_f32 v138, v178, v182
    v_bfi_b32 v138, s60, v63, v138
    v_mfma_f32_16x16x32_bf16 v[188:191], v[220:223], a[124:127], v[188:191]
    v_cvt_pk_bf16_f32 v142, v179, v183
    v_bfi_b32 v142, s60, v63, v142
    v_mfma_f32_16x16x32_bf16 v[244:247], v[68:71], v[208:211], 0
    v_mfma_f32_16x16x32_bf16 v[244:247], v[68:71], v[212:215], v[244:247]
    s_nop 3
    v_cvt_pk_bf16_f32 v131, v184, v188
    v_bfi_b32 v131, s60, v63, v131
    buffer_store_dwordx2 v[130:131], v48, s[4:7], 0 offen offset:128 sc1
    v_mfma_f32_16x16x32_bf16 v[244:247], v[68:71], v[216:219], v[244:247]
    v_cvt_pk_bf16_f32 v135, v185, v189
    v_bfi_b32 v135, s60, v63, v135
    buffer_store_dwordx2 v[134:135], v48, s[4:7], s56 offen offset:128 sc1
    v_mfma_f32_16x16x32_bf16 v[244:247], v[68:71], v[220:223], v[244:247]
    v_cvt_pk_bf16_f32 v139, v186, v190
    v_bfi_b32 v139, s60, v63, v139
    buffer_store_dwordx2 v[138:139], v48, s[4:7], s57 offen offset:128 sc1
    v_cvt_pk_bf16_f32 v143, v187, v191
    v_bfi_b32 v143, s60, v63, v143
    buffer_store_dwordx2 v[142:143], v48, s[4:7], s52 offen offset:128 sc1
    s_cmp_lg_u32 s34, 3
    s_barrier
    s_cbranch_scc1 L_kv_nf
    v_fma_f32 v229, v56, v61, v244
    s_mov_b64 exec, 0xffff
    buffer_store_dwordx4 v[228:231], v49, s[4:7], 0 offen sc1
    s_mov_b64 exec, -1
L_kv_nf:
    s_barrier
    buffer_load_dwordx4 v248, s[16:19], s53 offen nt lds
    buffer_load_dwordx4 v249, s[16:19], s53 offen offset:1024 nt lds
    buffer_load_dwordx4 v250, s[16:19], s53 offen offset:2048 nt lds
    buffer_load_dwordx4 v251, s[16:19], s53 offen offset:3072 nt lds
    s_branch L_pg8
.p2align 12
L_pg8:
    s_add_u32 s57, s59, 147456
    s_lshl4_add_u32 s50, s3, s33
    s_mul_i32 s50, s50, 3
    s_add_u32 s50, s50, s34
    s_lshl_b32 s50, s50, 11
    s_add_u32 s59, s50, 2490368
    v_and_b32 v29, 3, v1
    v_lshl_add_u32 v30, v2, 4, v29
    s_mul_i32 s50, s34, 48
    s_add_u32 s50, s50, s58
    v_add_lshl_u32 v31, v30, s50, 1
    s_cmp_lg_u32 s34, 3
    s_cbranch_scc1 L_kv_h
    s_mov_b32 m0, 40960
    s_nop 0
    buffer_load_dwordx4 v254, s[16:19], s57 offen nt lds
    s_branch L_kv_h2
L_kv_h:
    buffer_load_ushort v32, v31, s[24:27], 0 offen
    buffer_load_dwordx4 v[64:67], v3, s[4:7], s59 offen sc1
    buffer_load_dwordx4 v[68:71], v3, s[4:7], s59 offen offset:1024 sc1
L_kv_h2:
    s_add_u32 m0, s62, 4096
    s_nop 0
    buffer_load_dwordx4 v254, s[16:19], s53 offen nt lds
    s_add_u32 m0, s62, 4096
    s_nop 0
    buffer_load_dwordx4 v255, s[16:19], s53 offen offset:1024 nt lds
    s_add_u32 m0, s62, 4096
    s_nop 0
    buffer_load_dwordx4 v224, s[16:19], s53 offen offset:2048 nt lds
    s_add_u32 m0, s62, 4096
    s_nop 0
    buffer_load_dwordx4 v225, s[16:19], s53 offen offset:3072 nt lds
    s_add_u32 m0, s62, 8192
    s_nop 0
    buffer_load_dwordx4 v226, s[16:19], s53 offen nt lds
    s_lshl_b32 s51, s34, 10
    s_add_u32 m0, s51, 36864
    s_nop 0
    buffer_load_dwordx4 v7, s[16:19], s57 offen nt lds
L_pg9:
    s_mul_i32 s44, s3, 12
    s_add_u32 s44, s44, s33
    s_lshr_b32 s50, s44, 3
    s_mul_i32 s50, s50, 48
    s_and_b32 s51, s44, 3
    s_lshl2_add_u32 s50, s51, s50
    v_add_lshl_u32 v33, v30, s50, 1
    s_bfe_u32 s51, s44, 0x10002
    s_mul_i32 s48, s51, 1152
    v_lshlrev_b32 v34, 4, v0
    s_lshl_b32 s45, s44, 13
    s_add_u32 s46, s45, 3276800
    s_add_u32 s47, s46, 4096
    s_and_b32 s50, s44, 1
    s_mul_i32 s50, s50, 8128
    s_sub_u32 s46, s46, s50
    v_lshrrev_b32 v34, 2, v1
    v_lshlrev_b32 v34, 7, v34
    v_lshl_add_u32 v34, v29, 4, v34
    v_lshl_add_u32 v35, v2, 2, v29
    v_lshlrev_b32 v35, 4, v35
    v_add_u32 v35, 147968, v35
    s_lshl_b32 s50, s34, 2
    v_add_u32 v36, s50, v35
    v_lshrrev_b32 v72, 2, v1
    v_bfe_u32 v73, v1, 3, 2
    v_and_b32 v74, 3, v1
    v_lshlrev_b32 v74, 3, v74
    s_movk_i32 s50, 1152
    v_mad_u32_u24 v75, v72, s50, v74
    v_and_b32 v72, 3, v72
    v_mad_u32_u24 v76, v72, s50, v74
    v_add_u32 v76, 36864, v76
    v_lshrrev_b32 v72, 1, v72
    s_mul_i32 s50, s34, 9
    v_add_u32 v74, s50, v2
    v_xor_b32 v74, v74, v72
    v_lshl_add_u32 v22, v74, 5, v76
    v_xor_b32 v74, s50, v73
    v_lshl_add_u32 v18, v74, 5, v75
    s_add_u32 s50, s50, 1
    v_xor_b32 v74, s50, v73
    v_lshl_add_u32 v19, v74, 5, v75
    s_add_u32 s50, s50, 1
    v_xor_b32 v74, s50, v73
    v_lshl_add_u32 v20, v74, 5, v75
    s_add_u32 s50, s50, 1
    v_xor_b32 v74, s50, v73
    v_lshl_add_u32 v21, v74, 5, v75
    v_bfe_u32 v72, v1, 3, 2
    v_and_b32 v73, 112, v3
    v_lshl_add_u32 v72, v72, 14, v73
    s_mul_i32 s50, s34, 196608
    s_lshl4_add_u32 s51, s3, s33
    s_lshl_b32 s51, s51, 7
    s_add_u32 s50, s50, s51
    s_add_u32 s50, s50, 3276800
    v_add_u32 v26, s50, v72
    v_and_b32 v37, 4, v1
    v_mul_u32_u24 v38, 34, v37
    v_add_u32 v28, 147456, v38
    v_lshl_add_u32 v27, v2, 3, v28
    s_cmp_eq_u32 s34, 3
    s_cbranch_scc1 L_kv_nx3
    s_mov_b32 s54, 0
    s_waitcnt vmcnt(6)
L_hm:
    v_bitop3_b32 v39, v67, v71, s36 bitop3:0x7e
    v_cmp_ne_u32 vcc, 0, v39
    s_cbranch_vccz L_hm_done
    buffer_load_dwordx4 v[64:67], v3, s[4:7], s59 offen sc1
    buffer_load_dwordx4 v[68:71], v3, s[4:7], s59 offen offset:1024 sc1
    s_add_u32 s54, s54, 1
    s_cmp_le_u32 s54, 131072
    s_waitcnt vmcnt(0)
    s_cbranch_scc1 L_hm
L_hm_done:
    v_permlane32_swap_b32 v64, v66
    v_permlane32_swap_b32 v65, v67
    v_add_f32 v64, v64, v66
    v_add_f32 v65, v65, v67
    s_nop 1
    v_permlane16_swap_b32 v64, v65
    v_add_f32 v64, v64, v65
    s_nop 1
    v_add_f32_dpp v64, v64, v64 row_ror:4 row_mask:0xf bank_mask:0xf
    s_nop 1
    v_add_f32_dpp v64, v64, v64 row_ror:8 row_mask:0xf bank_mask:0xf
    v_permlane32_swap_b32 v68, v70
    v_permlane32_swap_b32 v69, v71
    v_add_f32 v68, v68, v70
    v_add_f32 v69, v69, v71
    s_nop 1
    v_permlane16_swap_b32 v68, v69
    v_add_f32 v68, v68, v69
    s_nop 1
    v_add_f32_dpp v68, v68, v68 row_ror:4 row_mask:0xf bank_mask:0xf
    s_nop 1
    v_add_f32_dpp v68, v68, v68 row_ror:8 row_mask:0xf bank_mask:0xf
    v_cmp_ne_u32 vcc, 0, v37
    v_lshlrev_b32 v32, 16, v32
    s_nop 0
    v_cndmask_b32 v64, v64, v68, vcc
    v_cvt_pk_bf16_f32 v64, v64, v64
    v_and_b32 v64, 0xffff0000, v64
    v_add_f32 v64, v64, v32
    v_cvt_pk_bf16_f32 v64, v64, v64
    v_and_b32 v64, 0xffff0000, v64
    v_mul_f32 v65, v64, v64
    v_mov_b32 v66, 0xc0135761
    v_fmac_f32 v66, 0xbdd2d3e8, v65
    v_mul_f32 v65, v66, v64
    v_exp_f32 v65, v65
    s_nop 0
    v_add_f32 v65, 1.0, v65
    v_rcp_f32 v65, v65
    s_nop 0
    v_mul_f32 v64, v64, v65
    v_cvt_pk_bf16_f32 v64, v64, v64
    v_lshl_add_u32 v39, v29, 1, v27
    s_mul_i32 s50, s34, 24
    v_add_u32 v39, s50, v39
    s_mov_b32 exec_hi, 0xffff
    ds_write_b16 v39, v64
    s_mov_b32 exec_hi, -1
L_kv_nx3:
    s_cmp_ge_u32 s33, 12
    s_cbranch_scc1 L_kv_nx4
    buffer_load_ushort v40, v33, s[20:23], 0 offen
    buffer_load_ushort v41, v33, s[28:31], s48 offen
    s_waitcnt vmcnt(2)
    s_branch L_kv_nx5
L_kv_nx4:
    s_waitcnt vmcnt(0)
L_kv_nx5:
    s_waitcnt lgkmcnt(0)
    s_barrier
    ds_read2_b64 v[192:195], v27 offset1:4
    ds_read_b64 v[196:197], v28 offset:64
    ds_read_b64_tr_b16 v[64:65], v18 offset:0
    ds_read_b64_tr_b16 v[66:67], v18 offset:18432
    ds_read_b64_tr_b16 v[70:71], v19 offset:0
    ds_read_b64_tr_b16 v[72:73], v19 offset:18432
    ds_read_b64_tr_b16 v[76:77], v20 offset:0
    ds_read_b64_tr_b16 v[78:79], v20 offset:18432
    ds_read_b64_tr_b16 v[68:69], v22 offset:0
    ds_read_b64_tr_b16 v[74:75], v22 offset:128
    ds_read_b64_tr_b16 v[80:81], v22 offset:256
    ds_read_b64_tr_b16 v[82:83], v21 offset:0
    ds_read_b64_tr_b16 v[84:85], v21 offset:18432
    v_and_b32 v198, 3, v1
    v_cmp_eq_u32 vcc, v198, v2
    s_mov_b32 s50, 65536
    s_mov_b32 s61, 131072
    v_mov_b32 v203, s36
    v_mov_b32 v207, s36
    v_mov_b32 v211, s36
    s_waitcnt lgkmcnt(11)
    v_cndmask_b32 v196, 0, v196, vcc
    v_cndmask_b32 v197, 0, v197, vcc
    s_waitcnt lgkmcnt(9)
    v_mfma_f32_16x16x32_bf16 v[120:123], v[192:195], v[64:67], 0
    ds_read_b64_tr_b16 v[88:89], v18 offset:128
    ds_read_b64_tr_b16 v[90:91], v18 offset:18560
    s_waitcnt lgkmcnt(9)
    v_mfma_f32_16x16x32_bf16 v[124:127], v[192:195], v[70:73], 0
    ds_read_b64_tr_b16 v[94:95], v19 offset:128
    ds_read_b64_tr_b16 v[96:97], v19 offset:18560
    s_waitcnt lgkmcnt(9)
    v_mfma_f32_16x16x32_bf16 v[128:131], v[192:195], v[76:79], 0
    ds_read_b64_tr_b16 v[100:101], v20 offset:128
    ds_read_b64_tr_b16 v[102:103], v20 offset:18560
    s_waitcnt lgkmcnt(10)
    v_mfma_f32_16x16x16_bf16 v[156:159], v[196:197], v[68:69], 0
    ds_read_b64_tr_b16 v[106:107], v21 offset:128
    ds_read_b64_tr_b16 v[108:109], v21 offset:18560
    s_waitcnt lgkmcnt(11)
    v_mfma_f32_16x16x16_bf16 v[160:163], v[196:197], v[74:75], 0
    ds_read_b64_tr_b16 v[112:113], v18 offset:256
    ds_read_b64_tr_b16 v[114:115], v18 offset:18688
    s_waitcnt lgkmcnt(12)
    v_mfma_f32_16x16x16_bf16 v[164:167], v[196:197], v[80:81], 0
    s_waitcnt lgkmcnt(4)
    s_mov_b32 exec_hi, 0
    v_mfma_f32_16x16x32_bf16 v[132:135], v[192:195], v[82:85], 0
    v_mfma_f32_16x16x32_bf16 v[136:139], v[192:195], v[88:91], 0
    v_mfma_f32_16x16x32_bf16 v[140:143], v[192:195], v[94:97], 0
    v_mfma_f32_16x16x32_bf16 v[144:147], v[192:195], v[100:103], 0
    v_add_f32 v200, v120, v156
    v_add_f32 v201, v124, v157
    v_add_f32 v202, v128, v158
    buffer_store_dwordx4 v[200:203], v26, s[4:7], 0 offen sc1
    s_waitcnt lgkmcnt(0)
    v_mfma_f32_16x16x32_bf16 v[148:151], v[192:195], v[106:109], 0
    v_mfma_f32_16x16x32_bf16 v[152:155], v[192:195], v[112:115], 0
    v_add_f32 v204, v132, v159
    v_add_f32 v205, v136, v160
    v_add_f32 v206, v140, v161
    buffer_store_dwordx4 v[204:207], v26, s[4:7], s50 offen sc1
    v_add_f32 v208, v144, v162
    s_nop 1
    v_add_f32 v209, v148, v163
    v_add_f32 v210, v152, v164
    buffer_store_dwordx4 v[208:211], v26, s[4:7], s61 offen sc1
    s_mov_b32 exec_hi, -1
    s_cmp_ge_u32 s33, 12
    s_cbranch_scc1 L_fin
    s_lshr_b32 s50, s34, 1
    s_mul_i32 s50, s50, 786432
    s_and_b32 s51, s34, 1
    s_lshl_b32 s51, s51, 13
    s_add_u32 s46, s46, s50
    s_add_u32 s46, s46, s51
    s_add_u32 s47, s46, 4096
    s_mov_b32 s54, 0
    s_cmp_ge_u32 s34, 4
    s_cbranch_scc1 L_f_m
    v_and_b32 v61, 7, v1
    v_lshlrev_b32 v61, 11, v61
    v_and_b32 v62, 0, v1
    v_lshl_add_u32 v61, v62, 4, v61
    s_lshl_b32 s50, s3, 8
    s_add_u32 s50, s50, 196608
L_f_h:
    buffer_load_dword v62, v61, s[4:7], s50 offen sc1
    s_add_u32 s54, s54, 1
    s_cmp_gt_u32 s54, 131072
    s_waitcnt vmcnt(0)
    s_cbranch_scc1 L_f_m
    v_cmp_ne_u32 vcc, s36, v62
    s_cbranch_vccnz L_f_h
L_f_m:
    buffer_load_dwordx4 v[64:67], v34, s[4:7], s46 offen offset:0 sc1
    buffer_load_dwordx4 v[68:71], v34, s[4:7], s46 offen offset:2048 sc1
    buffer_load_dwordx4 v[72:75], v34, s[4:7], s47 offen offset:0 sc1
    buffer_load_dwordx4 v[76:79], v34, s[4:7], s47 offen offset:2048 sc1
    s_add_u32 s54, s54, 1
    s_cmp_gt_u32 s54, 131072
    s_waitcnt vmcnt(0)
    s_cbranch_scc1 L_f_md
    v_bitop3_b32 v62, v67, v71, s36 bitop3:0x7e
    v_bitop3_b32 v63, v75, v79, s36 bitop3:0x7e
    v_or_b32 v62, v62, v63
    v_cmp_ne_u32 vcc, 0, v62
    s_nop 0
    s_and_b64 exec, exec, vcc
    s_cbranch_execnz L_f_m
L_f_md:
    s_mov_b64 exec, -1
    v_pk_add_f32 v[64:65], v[64:65], v[68:69]
    v_pk_add_f32 v[72:73], v[72:73], v[76:77]
    v_add_f32 v66, v66, v70
    v_add_f32 v74, v74, v78
    v_pk_add_f32 v[64:65], v[64:65], v[72:73]
    v_add_f32 v66, v66, v74
    s_nop 1
    v_permlane32_swap_b32 v64, v66
    v_permlane32_swap_b32 v65, v67
    v_add_f32 v64, v64, v66
    v_add_f32 v65, v65, v67
    s_nop 1
    v_permlane16_swap_b32 v64, v65
    v_add_f32 v64, v64, v65
    s_nop 1
    v_add_f32_dpp v64, v64, v64 row_ror:4 row_mask:0xf bank_mask:0xf
    s_nop 1
    v_add_f32_dpp v64, v64, v64 row_ror:8 row_mask:0xf bank_mask:0xf
    ds_write_b32 v36, v64
    v_lshlrev_b32 v40, 16, v40
    v_lshlrev_b32 v41, 16, v41
    s_waitcnt lgkmcnt(0)
    s_barrier
    ds_read_b128 v[64:67], v35
    s_waitcnt lgkmcnt(0)
    v_add_f32 v68, v64, v65
    v_add_f32 v64, v66, v67
    v_cvt_pk_bf16_f32 v64, v68, v64
    v_lshlrev_b32 v68, 16, v64
    v_add_f32 v68, v68, v40
    v_cvt_pk_bf16_f32 v68, v68, v68
    v_and_b32 v68, 0xffff0000, v68
    v_mul_f32 v65, 0xbfb8aa3b, v68
    v_exp_f32 v65, v65
    v_and_b32 v64, 0xffff0000, v64
    v_add_f32 v65, 1.0, v65
    v_rcp_f32 v65, v65
    s_nop 0
    v_mul_f32 v40, v68, v65
    v_cvt_pk_bf16_f32 v40, v40, v40
    v_and_b32 v40, 0xffff0000, v40
    v_mul_f32 v64, v64, v40
    v_cvt_pk_bf16_f32 v64, v64, v64
    v_and_b32 v64, 0xffff0000, v64
    v_add_f32 v64, v41, v64
    v_cvt_pk_bf16_f32 v64, v64, v64
    s_cmp_lg_u32 s34, 0
    s_cbranch_scc1 L_fin
    s_mov_b32 exec_lo, 0x000f000f
    s_mov_b32 exec_hi, 0x0000000f
    buffer_store_short v64, v33, s[40:43], s48 offen
    s_cmp_lg_u32 s44, 0
    s_cbranch_scc1 L_fin
    s_mov_b64 exec, 1
    v_mov_b32 v65, s36
    v_mov_b32 v66, 0
    buffer_store_dword v65, v66, s[4:7], 0 offen
L_fin:
L_end:
    s_endpgm
.section .rodata,"a"
.p2align 6
.amdhsa_kernel recurrent_scan__compressed_kv_cla__mixer_channel_mlp__decode_kernel
  .amdhsa_next_free_vgpr 512
  .amdhsa_next_free_sgpr 96
  .amdhsa_accum_offset 256
  .amdhsa_group_segment_fixed_size 0
  .amdhsa_kernarg_size 112
  .amdhsa_user_sgpr_count 2
  .amdhsa_user_sgpr_kernarg_segment_ptr 1
  .amdhsa_system_sgpr_workgroup_id_x 1
.end_amdhsa_kernel
```
